```python
import torch

def _softmax(x, axis=-1):
    return torch.softmax(x, dim=axis)
def _gelu(x):
    return torch.nn.functional.gelu(x, approximate="tanh")
def _silu(x):
    return torch.nn.functional.silu(x)
def _sigmoid(x):
    return torch.sigmoid(x)
def _layernorm(x, axis=-1, eps=1e-5):
    m = x.mean(dim=axis, keepdim=True)
    v = x.var(dim=axis, keepdim=True, unbiased=False)
    return (x - m) / torch.sqrt(v + eps)
def _scatter_add(tgt, idx, src, axis=0):
    return tgt.clone().index_add_(axis, idx, src)
def _segment_sum(src, seg, n):
    out = torch.zeros((n,) + src.shape[1:], dtype=src.dtype)
    return out.index_add_(0, seg, src)
def _pad(x, pw):
    flat = tuple(v for pair in reversed(pw) for v in pair)
    return torch.nn.functional.pad(x, flat)

kernel_name = 'gated_mix__linear_kernel_hedgehog__mixer_channel_mlp__prompt'

def setup_inputs():

    _w = (lambda a: (lambda t: t.to(torch.bfloat16) if t.is_floating_point() else t)(torch.as_tensor(a)))
    def _A_setup():
        B, S, D, H = 1, 2048, 512, 32
        Dh = D // H
        return {
            "x": _w((lambda *s: torch.randn(*s, dtype=torch.bfloat16) * 0.05)(B, S, D)),
            "wqkv": _w((lambda *s: torch.randn(*s, dtype=torch.bfloat16) * 0.8)(D, 3 * D)),
            "w_phi": _w((lambda *s: torch.randn(*s, dtype=torch.bfloat16) * 0.8)(H, Dh, Dh) * (Dh ** -0.5)),
            "wo": _w((lambda *s: torch.randn(*s, dtype=torch.bfloat16) * 0.1)(D, D)),
        }
    _A_in = _A_setup()

    def _B_setup():
        B, S, D, F = 1, 2048, 512, 1376
        return {
            "x": _w((lambda *s: torch.randn(*s, dtype=torch.bfloat16) * 0.05)(B, S, D)),
            "w1": _w((lambda *s: torch.randn(*s, dtype=torch.bfloat16) * 0.8)(D, F) * (D ** -0.5)),
            "b1": _w((lambda *s: torch.randn(*s, dtype=torch.bfloat16) * 0.4)(F)),
            "w2": _w((lambda *s: torch.randn(*s, dtype=torch.bfloat16) * 0.05)(F, D) * (F ** -0.5)),
            "b2": _w((lambda *s: torch.randn(*s, dtype=torch.bfloat16) * 0.05)(D)),
        }
    _B_in = _B_setup()

    return {
        "A_x": _A_in["x"],
        "A_wqkv": _A_in["wqkv"],
        "A_w_phi": _A_in["w_phi"],
        "A_wo": _A_in["wo"],
        "B_x": _B_in["x"],
        "B_w1": _B_in["w1"],
        "B_b1": _B_in["b1"],
        "B_w2": _B_in["w2"],
        "B_b2": _B_in["b2"],
        "gate_w": _w((lambda *s: torch.randn(*s, dtype=torch.bfloat16) * 0.05)(512) * 16.0),
    }

def reference(A_x, A_wqkv, A_w_phi, A_wo, B_x, B_w1, B_b1, B_w2, B_b2, gate_w):
    def _A_ref(x, wqkv, w_phi, wo):
        B, S, D = x.shape
        H = 32; Dh = D // H
        qkv = (lambda x, *d: x.permute(*d))((x @ wqkv).reshape(B, S, 3, H, Dh), 2, 0, 3, 1, 4)
        q, k, v = qkv[0], qkv[1], qkv[2]
        pq = torch.einsum("bhsd,hdf->bhsf", q, w_phi)
        pk = torch.einsum("bhsd,hdf->bhsf", k, w_phi)
        phi_q = torch.concatenate([_softmax(pq, axis=-1), _softmax(-pq, axis=-1)], axis=-1)
        phi_k = torch.concatenate([_softmax(pk, axis=-1), _softmax(-pk, axis=-1)], axis=-1)
        kv = torch.einsum("bhsf,bhsd->bhfd", phi_k, v)
        z  = torch.einsum("bhsf->bhf", phi_k)
        num = torch.einsum("bhqf,bhfd->bhqd", phi_q, kv)
        den = torch.einsum("bhqf,bhf->bhq", phi_q, z)[..., None] + 1e-6
        o = num / den
        return (lambda x, *d: x.permute(*d))(o, 0, 2, 1, 3).reshape(B, S, D) @ wo

    def _B_ref(x, w1, b1, w2, b2):
        y = _layernorm(x, axis=-1)
        h = _gelu(torch.einsum("bsd,df->bsf", y, w1) + b1)
        return torch.einsum("bsf,fd->bsd", h, w2) + b2

    x = A_x
    g = _sigmoid((x * gate_w).sum(-1, keepdims=True))
    a = _A_ref(x, A_wqkv, A_w_phi, A_wo)
    b = _B_ref(x, B_w1, B_b1, B_w2, B_b2)
    return g * a + (1 - g) * b
```

```asm
; @launch kernel=fused_kernel grid=(256,1,1) block=(512,1,1) lds=163840
.amdgcn_target "amdgcn-amd-amdhsa--gfx950"
.text
.globl fused_kernel
.p2align 8
.type fused_kernel,@function
fused_kernel:
    s_cmp_ge_u32 s2, 256
    s_cbranch_scc1 F_EXIT
    s_load_dwordx16 s[40:55], s[0:1], 0
    s_load_dwordx8 s[56:63], s[0:1], 64
    s_load_dwordx2 s[64:65], s[0:1], 96
    v_lshrrev_b32 v1, 6, v0
    v_and_b32 v2, 63, v0
    s_nop 0
    v_readfirstlane_b32 s30, v1
    s_mov_b32 s67, 0x3fb8aa3b
    s_mov_b32 s98, 256
    s_mov_b32 s99, 0x00020000
    s_mov_b32 s18, 0x10000000
    s_mov_b32 s19, 0x00020000
    s_getreg_b32 s28, hwreg(HW_REG_XCC_ID, 0, 4)
    s_and_b32 s28, s28, 7
    s_lshr_b32 s29, s28, 1
    s_lshl_b32 s29, s29, 6
    s_and_b32 s3, s28, 1
    s_lshl_b32 s3, s3, 2
    s_add_u32 s29, s29, s3
    v_mov_b32 v8, s29
    v_mov_b32 v9, 1
    s_mov_b64 s[6:7], exec
    s_and_b32 s3, s2, 7
    s_lshr_b32 s4, s2, 3
    s_and_b32 s5, s3, 1
    s_lshl_b32 s28, s5, 3
    s_and_b32 s6, s4, 7
    s_add_u32 s28, s28, s6
    s_lshr_b32 s6, s3, 1
    s_and_b32 s6, s6, 1
    s_lshl_b32 s29, s6, 2
    s_lshr_b32 s6, s4, 3
    s_add_u32 s29, s29, s6
    s_lshl_b32 s33, s5, 4
    s_lshr_b32 s6, s3, 1
    s_lshl_b32 s6, s6, 2
    s_add_u32 s33, s33, s6
    s_and_b32 s6, s4, 3
    s_add_u32 s33, s33, s6
    s_lshr_b32 s69, s4, 2
    s_xor_b32 s69, s69, 0
    s_lshr_b32 s31, s30, 2
    s_and_b32 s32, s30, 3
    s_lshl_b32 s37, s30, 11
    s_lshl_b32 s38, s30, 10
    s_add_u32 s38, s38, 16384
    s_mov_b32 s66, 0x3fb8aa3b
    s_lshr_b32 s3, s3, 2
    s_cmp_eq_u32 s3, 1
    s_cbranch_scc1 F_HTYPE
    s_lshl_b32 s34, s29, 7
    s_add_u32 s35, s34, 1024
    s_add_u32 s36, s34, 2048
    v_and_b32 v3, 15, v2
    v_lshrrev_b32 v4, 4, v2
    v_and_b32 v5, 7, v2
    v_lshrrev_b32 v6, 3, v2
    s_lshl_b32 s3, s30, 4
    v_add_u32 v7, s3, v6
    v_lshlrev_b32 v7, 10, v7
    v_xor_b32 v8, v5, v6
    v_lshl_add_u32 v10, v8, 4, v7
    s_lshl_b32 s3, s30, 3
    v_add_u32 v7, s3, v6
    s_movk_i32 s3, 3072
    v_mul_lo_u32 v7, v7, s3
    v_and_b32 v8, 1, v4
    v_lshlrev_b32 v8, 1, v8
    s_and_b32 s3, s30, 1
    s_lshl_b32 s3, s3, 2
    v_or_b32 v8, s3, v8
    v_xor_b32 v8, v5, v8
    v_lshl_add_u32 v11, v8, 4, v7
    s_waitcnt lgkmcnt(0)
    s_mov_b32 s0, 1
    s_and_b32 s1, s28, 7
    s_lshl_b32 s3, s28, 17
    s_add_u32 s8, s40, s3
    s_addc_u32 s9, s41, 0
    s_mov_b32 s10, 0x20000
    s_mov_b32 s11, 0x00020000
    s_mov_b32 s12, s42
    s_mov_b32 s13, s43
    s_mov_b32 s14, 1572864
    s_mov_b32 s15, 0x00020000
    s_add_u32 s48, s1, 0
    s_and_b32 s48, s48, 7
    s_lshl_b32 s49, s48, 7
    s_mul_i32 s48, s48, 196608
    s_add_u32 m0, s37, 0
    s_nop 0
    buffer_load_dwordx4 v10, s[8:11], s49 offen lds
    s_add_u32 m0, s37, 1024
    s_add_u32 s49, s49, 8192
    buffer_load_dwordx4 v10, s[8:11], s49 offen lds
    s_add_u32 m0, s38, 0
    s_add_u32 s39, s34, s48
    buffer_load_dwordx4 v11, s[12:15], s39 offen lds
    s_add_u32 m0, s38, 8192
    s_add_u32 s39, s35, s48
    buffer_load_dwordx4 v11, s[12:15], s39 offen lds
    s_add_u32 m0, s38, 16384
    s_add_u32 s39, s36, s48
    buffer_load_dwordx4 v11, s[12:15], s39 offen lds
    s_mov_b32 s16, s64
    s_mov_b32 s17, s65
    s_mov_b32 s96, s62
    s_mov_b32 s97, s63
    s_cmp_lg_u32 s2, 0
    s_cbranch_scc1 F_NOCLR0
    v_mov_b32 v20, 0
    v_mov_b32 v21, 0
    v_mov_b32 v22, 0
    v_mov_b32 v23, 0
    v_lshlrev_b32 v24, 4, v0
    v_add_u32 v24, 13107200, v24
    v_add_u32 v25, 8192, v24
    buffer_store_dwordx4 v[20:23], v24, s[16:19], 0 offen sc1
    buffer_store_dwordx4 v[20:23], v25, s[16:19], 0 offen sc1
    s_mov_b64 s[6:7], exec
    s_lshl_b32 s3, s30, 2
    v_mov_b32 v24, s3
    v_mov_b32 v25, 1
    s_waitcnt vmcnt(0)
    s_mov_b64 exec, 1
    buffer_store_dword v25, v24, s[96:99], 0 offen offset:32 sc1
    s_mov_b64 exec, s[6:7]
F_NOCLR0:
    s_cmp_lg_u32 s30, 7
    s_cbranch_scc1 F_NOZA
    s_mul_i32 s3, s29, 8704
    s_mul_i32 s4, s28, 544
    s_add_u32 s3, s3, s4
    s_add_u32 s3, s3, 10485760
    v_lshl_add_u32 v7, v2, 4, s3
    v_mov_b32 v20, 0
    v_mov_b32 v21, 0
    v_mov_b32 v22, 0
    v_mov_b32 v23, 0
    s_mov_b64 s[6:7], exec
    s_mov_b32 exec_lo, -1
    s_mov_b32 exec_hi, 3
    buffer_store_dwordx4 v[20:23], v7, s[16:19], 0 offen sc1
    s_mov_b64 exec, s[6:7]
F_NOZA:
    s_mov_b32 s96, s62
    s_mov_b32 s97, s63
    s_mov_b32 s98, 256
    s_mov_b32 s99, 0x00020000
    s_mov_b32 s24, s58
    s_mov_b32 s25, s59
    s_mov_b32 s26, 1024
    s_mov_b32 s27, 0x00020000
    s_mov_b32 s20, s44
    s_mov_b32 s21, s45
    s_mov_b32 s22, 16384
    s_mov_b32 s23, 0x00020000
    v_and_b32 v7, 6, v6
    v_xor_b32 v7, v5, v7
    v_lshlrev_b32 v7, 4, v7
    v_lshl_add_u32 v12, v6, 10, v7
    s_lshl_b32 s3, s69, 7
    v_add_u32 v12, s3, v12
    s_lshl_b32 s3, s29, 2
    s_add_u32 s68, s3, s32
    s_lshl_b32 s3, s68, 9
    v_lshlrev_b32 v7, 7, v4
    v_lshl_add_u32 v7, v3, 1, v7
    v_add_u32 v7, s3, v7
    buffer_load_ushort v16, v7, s[20:23], 0 offen
    buffer_load_ushort v17, v7, s[20:23], 0 offen offset:32
    buffer_load_ushort v18, v7, s[20:23], 0 offen offset:64
    buffer_load_ushort v19, v7, s[20:23], 0 offen offset:96
    s_lshl_b32 s3, s29, 3
    s_add_u32 s3, s3, s30
    s_add_u32 s3, s3, 0
    s_lshl_b32 s4, s3, 10
    v_lshlrev_b32 v7, 4, v2
    buffer_load_dwordx4 v[20:23], v7, s[8:11], s4 offen
    buffer_load_dwordx4 v[24:27], v7, s[24:27], 0 offen
    s_lshl_b32 s4, s28, 7
    s_add_u32 s3, s3, s4
    s_lshl_b32 s3, s3, 4
    s_add_u32 s101, s3, 13041664
    s_xor_b32 s3, s31, 0
    s_lshl_b32 s3, s3, 2
    v_add_u32 v7, s3, v4
    v_xor_b32 v7, v7, v5
    v_lshlrev_b32 v7, 4, v7
    v_lshl_add_u32 v7, v3, 7, v7
    s_add_u32 s3, s32, 0
    s_and_b32 s3, s3, 3
    s_lshl_b32 s3, s3, 11
    s_lshl_b32 s4, s31, 13
    s_add_u32 s3, s3, s4
    v_add_u32 v40, s3, v7
    v_add_u32 v48, 81920, v40
    s_add_u32 s3, s32, 1
    s_and_b32 s3, s3, 3
    s_lshl_b32 s3, s3, 11
    s_lshl_b32 s4, s31, 13
    s_add_u32 s3, s3, s4
    v_add_u32 v41, s3, v7
    v_add_u32 v49, 81920, v41
    s_add_u32 s3, s32, 2
    s_and_b32 s3, s3, 3
    s_lshl_b32 s3, s3, 11
    s_lshl_b32 s4, s31, 13
    s_add_u32 s3, s3, s4
    v_add_u32 v42, s3, v7
    v_add_u32 v50, 81920, v42
    s_add_u32 s3, s32, 3
    s_and_b32 s3, s3, 3
    s_lshl_b32 s3, s3, 11
    s_lshl_b32 s4, s31, 13
    s_add_u32 s3, s3, s4
    v_add_u32 v43, s3, v7
    v_add_u32 v51, 81920, v43
    s_xor_b32 s3, s31, 1
    s_lshl_b32 s3, s3, 2
    v_add_u32 v7, s3, v4
    v_xor_b32 v7, v7, v5
    v_lshlrev_b32 v7, 4, v7
    v_lshl_add_u32 v7, v3, 7, v7
    s_add_u32 s3, s32, 0
    s_and_b32 s3, s3, 3
    s_lshl_b32 s3, s3, 11
    s_lshl_b32 s4, s31, 13
    s_add_u32 s3, s3, s4
    v_add_u32 v44, s3, v7
    v_add_u32 v52, 81920, v44
    s_add_u32 s3, s32, 1
    s_and_b32 s3, s3, 3
    s_lshl_b32 s3, s3, 11
    s_lshl_b32 s4, s31, 13
    s_add_u32 s3, s3, s4
    v_add_u32 v45, s3, v7
    v_add_u32 v53, 81920, v45
    s_add_u32 s3, s32, 2
    s_and_b32 s3, s3, 3
    s_lshl_b32 s3, s3, 11
    s_lshl_b32 s4, s31, 13
    s_add_u32 s3, s3, s4
    v_add_u32 v46, s3, v7
    v_add_u32 v54, 81920, v46
    s_add_u32 s3, s32, 3
    s_and_b32 s3, s3, 3
    s_lshl_b32 s3, s3, 11
    s_lshl_b32 s4, s31, 13
    s_add_u32 s3, s3, s4
    v_add_u32 v47, s3, v7
    v_add_u32 v55, 81920, v47
    v_lshrrev_b32 v68, 2, v3
    v_lshrrev_b32 v69, 1, v68
    v_and_b32 v7, 1, v4
    v_lshl_or_b32 v69, v7, 1, v69
    v_lshl_add_u32 v70, v4, 3, v68
    v_lshlrev_b32 v70, 7, v70
    v_and_b32 v7, 3, v3
    v_lshl_add_u32 v70, v7, 3, v70
    s_mov_b32 s4, s32
    s_movk_i32 s5, 0
    v_xor_b32 v7, s4, v69
    v_lshl_add_u32 v7, v7, 5, v70
    s_xor_b32 s3, s31, 0
    s_lshl_b32 s3, s3, 12
    s_add_u32 s3, s3, s5
    s_add_u32 s3, s3, 16384
    v_add_u32 v56, s3, v7
    s_xor_b32 s3, s31, 0
    s_lshl_b32 s3, s3, 12
    s_add_u32 s3, s3, s5
    s_add_u32 s3, s3, 98304
    v_add_u32 v57, s3, v7
    s_xor_b32 s3, s31, 1
    s_lshl_b32 s3, s3, 12
    s_add_u32 s3, s3, s5
    s_add_u32 s3, s3, 16384
    v_add_u32 v58, s3, v7
    s_xor_b32 s3, s31, 1
    s_lshl_b32 s3, s3, 12
    s_add_u32 s3, s3, s5
    s_add_u32 s3, s3, 98304
    v_add_u32 v59, s3, v7
    s_mov_b32 s4, s32
    s_movk_i32 s5, 8192
    v_xor_b32 v7, s4, v69
    v_lshl_add_u32 v7, v7, 5, v70
    s_xor_b32 s3, s31, 0
    s_lshl_b32 s3, s3, 12
    s_add_u32 s3, s3, s5
    s_add_u32 s3, s3, 16384
    v_add_u32 v60, s3, v7
    s_xor_b32 s3, s31, 0
    s_lshl_b32 s3, s3, 12
    s_add_u32 s3, s3, s5
    s_add_u32 s3, s3, 98304
    v_add_u32 v61, s3, v7
    s_xor_b32 s3, s31, 1
    s_lshl_b32 s3, s3, 12
    s_add_u32 s3, s3, s5
    s_add_u32 s3, s3, 16384
    v_add_u32 v62, s3, v7
    s_xor_b32 s3, s31, 1
    s_lshl_b32 s3, s3, 12
    s_add_u32 s3, s3, s5
    s_add_u32 s3, s3, 98304
    v_add_u32 v63, s3, v7
    s_mov_b32 s4, s32
    s_movk_i32 s5, 16384
    v_xor_b32 v7, s4, v69
    v_lshl_add_u32 v7, v7, 5, v70
    s_xor_b32 s3, s31, 0
    s_lshl_b32 s3, s3, 12
    s_add_u32 s3, s3, s5
    s_add_u32 s3, s3, 16384
    v_add_u32 v64, s3, v7
    s_xor_b32 s3, s31, 0
    s_lshl_b32 s3, s3, 12
    s_add_u32 s3, s3, s5
    s_add_u32 s3, s3, 98304
    v_add_u32 v65, s3, v7
    s_xor_b32 s3, s31, 1
    s_lshl_b32 s3, s3, 12
    s_add_u32 s3, s3, s5
    s_add_u32 s3, s3, 16384
    v_add_u32 v66, s3, v7
    s_xor_b32 s3, s31, 1
    s_lshl_b32 s3, s3, 12
    s_add_u32 s3, s3, s5
    s_add_u32 s3, s3, 98304
    v_add_u32 v67, s3, v7
    s_add_u32 s48, s1, 1
    s_and_b32 s48, s48, 7
    s_lshl_b32 s49, s48, 7
    s_mul_i32 s48, s48, 196608
    s_add_u32 m0, s37, 40960
    s_nop 0
    buffer_load_dwordx4 v10, s[8:11], s49 offen lds
    s_add_u32 m0, s37, 41984
    s_add_u32 s49, s49, 8192
    buffer_load_dwordx4 v10, s[8:11], s49 offen lds
    s_add_u32 m0, s38, 40960
    s_add_u32 s39, s34, s48
    buffer_load_dwordx4 v11, s[12:15], s39 offen lds
    s_add_u32 m0, s38, 49152
    s_add_u32 s39, s35, s48
    buffer_load_dwordx4 v11, s[12:15], s39 offen lds
    s_add_u32 m0, s38, 57344
    s_add_u32 s39, s36, s48
    buffer_load_dwordx4 v11, s[12:15], s39 offen lds
    v_mov_b32 v72, 0
    v_mov_b32 v73, 0
    v_mov_b32 v74, 0
    v_mov_b32 v75, 0
    v_mov_b32 v76, 0
    v_mov_b32 v77, 0
    v_mov_b32 v78, 0
    v_mov_b32 v79, 0
    v_mov_b32 v80, 0
    v_mov_b32 v81, 0
    v_mov_b32 v82, 0
    v_mov_b32 v83, 0
    v_mov_b32 v84, 0
    v_mov_b32 v85, 0
    v_mov_b32 v86, 0
    v_mov_b32 v87, 0
    v_mov_b32 v88, 0
    v_mov_b32 v89, 0
    v_mov_b32 v90, 0
    v_mov_b32 v91, 0
    v_mov_b32 v92, 0
    v_mov_b32 v93, 0
    v_mov_b32 v94, 0
    v_mov_b32 v95, 0
    v_mov_b32 v96, 0
    v_mov_b32 v97, 0
    v_mov_b32 v98, 0
    v_mov_b32 v99, 0
    v_mov_b32 v100, 0
    v_mov_b32 v101, 0
    v_mov_b32 v102, 0
    v_mov_b32 v103, 0
    v_mov_b32 v104, 0
    v_mov_b32 v105, 0
    v_mov_b32 v106, 0
    v_mov_b32 v107, 0
    v_mov_b32 v108, 0
    v_mov_b32 v109, 0
    v_mov_b32 v110, 0
    v_mov_b32 v111, 0
    v_mov_b32 v112, 0
    v_mov_b32 v113, 0
    v_mov_b32 v114, 0
    v_mov_b32 v115, 0
    v_mov_b32 v116, 0
    v_mov_b32 v117, 0
    v_mov_b32 v118, 0
    v_mov_b32 v119, 0
    s_waitcnt vmcnt(5)
    s_barrier
    ds_read_b64_tr_b16 v[152:153], v56 offset:0
    ds_read_b64_tr_b16 v[154:155], v56 offset:512
    ds_read_b128 v[120:123], v40 offset:0
    ds_read_b128 v[124:127], v41 offset:0
    ds_read_b128 v[128:131], v42 offset:0
    ds_read_b128 v[132:135], v43 offset:0
    ds_read_b64_tr_b16 v[156:157], v60 offset:0
    ds_read_b64_tr_b16 v[158:159], v60 offset:512
    ds_read_b64_tr_b16 v[160:161], v64 offset:0
    ds_read_b64_tr_b16 v[162:163], v64 offset:512
    s_waitcnt lgkmcnt(0)
    v_mfma_f32_16x16x32_bf16 v[72:75], v[152:155], v[120:123], v[72:75]
    ds_read_b64_tr_b16 v[164:165], v58 offset:0
    ds_read_b64_tr_b16 v[166:167], v58 offset:512
    ds_read_b128 v[136:139], v44 offset:0
    v_mfma_f32_16x16x32_bf16 v[76:79], v[152:155], v[124:127], v[76:79]
    ds_read_b128 v[140:143], v45 offset:0
    ds_read_b128 v[144:147], v46 offset:0
    ds_read_b128 v[148:151], v47 offset:0
    v_mfma_f32_16x16x32_bf16 v[80:83], v[152:155], v[128:131], v[80:83]
    ds_read_b64_tr_b16 v[168:169], v62 offset:0
    ds_read_b64_tr_b16 v[170:171], v62 offset:512
    ds_read_b64_tr_b16 v[172:173], v66 offset:0
    v_mfma_f32_16x16x32_bf16 v[84:87], v[152:155], v[132:135], v[84:87]
    ds_read_b64_tr_b16 v[174:175], v66 offset:512
    s_add_u32 s48, s1, 2
    s_and_b32 s48, s48, 7
    v_mfma_f32_16x16x32_bf16 v[88:91], v[156:159], v[120:123], v[88:91]
    s_lshl_b32 s49, s48, 7
    s_mul_i32 s48, s48, 196608
    s_add_u32 m0, s37, 81920
    v_mfma_f32_16x16x32_bf16 v[92:95], v[156:159], v[124:127], v[92:95]
    buffer_load_dwordx4 v10, s[8:11], s49 offen lds
    s_add_u32 m0, s37, 82944
    s_add_u32 s49, s49, 8192
    v_mfma_f32_16x16x32_bf16 v[96:99], v[156:159], v[128:131], v[96:99]
    buffer_load_dwordx4 v10, s[8:11], s49 offen lds
    s_add_u32 m0, s38, 81920
    s_add_u32 s39, s34, s48
    v_mfma_f32_16x16x32_bf16 v[100:103], v[156:159], v[132:135], v[100:103]
    buffer_load_dwordx4 v11, s[12:15], s39 offen lds
    s_add_u32 m0, s38, 90112
    s_add_u32 s39, s35, s48
    v_mfma_f32_16x16x32_bf16 v[104:107], v[120:123], v[160:163], v[104:107]
    buffer_load_dwordx4 v11, s[12:15], s39 offen lds
    s_add_u32 m0, s38, 98304
    s_add_u32 s39, s36, s48
    v_mfma_f32_16x16x32_bf16 v[108:111], v[124:127], v[160:163], v[108:111]
    buffer_load_dwordx4 v11, s[12:15], s39 offen lds
    v_lshlrev_b32 v28, 16, v20
    v_and_b32 v29, 0xffff0000, v20
    v_mfma_f32_16x16x32_bf16 v[112:115], v[128:131], v[160:163], v[112:115]
    v_lshlrev_b32 v30, 16, v24
    v_and_b32 v31, 0xffff0000, v24
    v_mov_b32 v32, v28
    v_mfma_f32_16x16x32_bf16 v[116:119], v[132:135], v[160:163], v[116:119]
    v_mov_b32 v33, v29
    v_mul_f32 v34, v28, v28
    v_mul_f32 v35, v29, v29
    v_mul_f32 v36, v28, v30
    v_mul_f32 v37, v29, v31
    v_lshlrev_b32 v28, 16, v21
    v_and_b32 v29, 0xffff0000, v21
    v_lshlrev_b32 v30, 16, v25
    v_and_b32 v31, 0xffff0000, v25
    v_add_f32 v32, v32, v28
    v_add_f32 v33, v33, v29
    v_fma_f32 v34, v28, v28, v34
    v_fma_f32 v35, v29, v29, v35
    v_fma_f32 v36, v28, v30, v36
    v_fma_f32 v37, v29, v31, v37
    v_lshlrev_b32 v28, 16, v22
    v_and_b32 v29, 0xffff0000, v22
    v_lshlrev_b32 v30, 16, v26
    v_and_b32 v31, 0xffff0000, v26
    v_add_f32 v32, v32, v28
    v_add_f32 v33, v33, v29
    v_fma_f32 v34, v28, v28, v34
    v_fma_f32 v35, v29, v29, v35
    v_fma_f32 v36, v28, v30, v36
    v_fma_f32 v37, v29, v31, v37
    s_waitcnt vmcnt(5) lgkmcnt(0)
    s_barrier
    v_mfma_f32_16x16x32_bf16 v[72:75], v[164:167], v[136:139], v[72:75]
    ds_read_b64_tr_b16 v[152:153], v56 offset:40960
    ds_read_b64_tr_b16 v[154:155], v56 offset:41472
    ds_read_b128 v[120:123], v40 offset:40960
    v_mfma_f32_16x16x32_bf16 v[76:79], v[164:167], v[140:143], v[76:79]
    ds_read_b128 v[124:127], v41 offset:40960
    ds_read_b128 v[128:131], v42 offset:40960
    ds_read_b128 v[132:135], v43 offset:40960
    v_mfma_f32_16x16x32_bf16 v[80:83], v[164:167], v[144:147], v[80:83]
    ds_read_b64_tr_b16 v[156:157], v60 offset:40960
    ds_read_b64_tr_b16 v[158:159], v60 offset:41472
    ds_read_b64_tr_b16 v[160:161], v64 offset:40960
    v_mfma_f32_16x16x32_bf16 v[84:87], v[164:167], v[148:151], v[84:87]
    ds_read_b64_tr_b16 v[162:163], v64 offset:41472
    s_add_u32 s48, s1, 3
    s_and_b32 s48, s48, 7
    v_mfma_f32_16x16x32_bf16 v[88:91], v[168:171], v[136:139], v[88:91]
    s_lshl_b32 s49, s48, 7
    s_mul_i32 s48, s48, 196608
    s_add_u32 m0, s37, 122880
    v_mfma_f32_16x16x32_bf16 v[92:95], v[168:171], v[140:143], v[92:95]
    buffer_load_dwordx4 v10, s[8:11], s49 offen lds
    s_add_u32 m0, s37, 123904
    s_add_u32 s49, s49, 8192
    v_mfma_f32_16x16x32_bf16 v[96:99], v[168:171], v[144:147], v[96:99]
    buffer_load_dwordx4 v10, s[8:11], s49 offen lds
    s_add_u32 m0, s38, 122880
    s_add_u32 s39, s34, s48
    v_mfma_f32_16x16x32_bf16 v[100:103], v[168:171], v[148:151], v[100:103]
    buffer_load_dwordx4 v11, s[12:15], s39 offen lds
    s_add_u32 m0, s38, 131072
    s_add_u32 s39, s35, s48
    v_mfma_f32_16x16x32_bf16 v[104:107], v[136:139], v[172:175], v[104:107]
    buffer_load_dwordx4 v11, s[12:15], s39 offen lds
    s_add_u32 m0, s38, 139264
    s_add_u32 s39, s36, s48
    v_mfma_f32_16x16x32_bf16 v[108:111], v[140:143], v[172:175], v[108:111]
    buffer_load_dwordx4 v11, s[12:15], s39 offen lds
    s_add_u32 s48, s1, 4
    s_and_b32 s48, s48, 7
    v_mfma_f32_16x16x32_bf16 v[112:115], v[144:147], v[172:175], v[112:115]
    s_lshl_b32 s49, s48, 7
    s_mul_i32 s48, s48, 196608
    s_add_u32 m0, s37, 0
    v_mfma_f32_16x16x32_bf16 v[116:119], v[148:151], v[172:175], v[116:119]
    buffer_load_dwordx4 v10, s[8:11], s49 offen lds
    s_add_u32 m0, s37, 1024
    s_add_u32 s49, s49, 8192
    buffer_load_dwordx4 v10, s[8:11], s49 offen lds
    s_add_u32 m0, s38, 0
    s_add_u32 s39, s34, s48
    buffer_load_dwordx4 v11, s[12:15], s39 offen lds
    s_add_u32 m0, s38, 8192
    s_add_u32 s39, s35, s48
    buffer_load_dwordx4 v11, s[12:15], s39 offen lds
    s_add_u32 m0, s38, 16384
    s_add_u32 s39, s36, s48
    buffer_load_dwordx4 v11, s[12:15], s39 offen lds
    v_lshlrev_b32 v28, 16, v23
    v_and_b32 v29, 0xffff0000, v23
    v_lshlrev_b32 v30, 16, v27
    v_and_b32 v31, 0xffff0000, v27
    v_add_f32 v32, v32, v28
    v_add_f32 v33, v33, v29
    v_fma_f32 v34, v28, v28, v34
    v_fma_f32 v35, v29, v29, v35
    v_fma_f32 v36, v28, v30, v36
    v_fma_f32 v37, v29, v31, v37
    v_add_f32 v32, v32, v33
    v_add_f32 v34, v34, v35
    v_add_f32 v36, v36, v37
    v_add_f32_dpp v32, v32, v32 row_ror:8 row_mask:0xf bank_mask:0xf
    v_add_f32_dpp v34, v34, v34 row_ror:8 row_mask:0xf bank_mask:0xf
    v_add_f32_dpp v36, v36, v36 row_ror:8 row_mask:0xf bank_mask:0xf
    v_add_f32_dpp v32, v32, v32 row_ror:4 row_mask:0xf bank_mask:0xf
    v_add_f32_dpp v34, v34, v34 row_ror:4 row_mask:0xf bank_mask:0xf
    v_add_f32_dpp v36, v36, v36 row_ror:4 row_mask:0xf bank_mask:0xf
    v_add_f32_dpp v32, v32, v32 row_ror:2 row_mask:0xf bank_mask:0xf
    v_add_f32_dpp v34, v34, v34 row_ror:2 row_mask:0xf bank_mask:0xf
    v_add_f32_dpp v36, v36, v36 row_ror:2 row_mask:0xf bank_mask:0xf
    v_add_f32_dpp v32, v32, v32 row_ror:1 row_mask:0xf bank_mask:0xf
    v_add_f32_dpp v34, v34, v34 row_ror:1 row_mask:0xf bank_mask:0xf
    v_add_f32_dpp v36, v36, v36 row_ror:1 row_mask:0xf bank_mask:0xf
    s_nop 0
    v_permlane32_swap_b32 v32, v34
    v_add_f32 v28, v32, v34
    v_mov_b32 v29, v28
    s_nop 1
    v_permlane16_swap_b32 v28, v29
    v_add_f32 v32, v28, v29
    s_waitcnt lgkmcnt(0)
    v_mfma_f32_16x16x32_bf16 v[72:75], v[152:155], v[120:123], v[72:75]
    ds_read_b64_tr_b16 v[164:165], v58 offset:40960
    ds_read_b64_tr_b16 v[166:167], v58 offset:41472
    ds_read_b128 v[136:139], v44 offset:40960
    v_mfma_f32_16x16x32_bf16 v[76:79], v[152:155], v[124:127], v[76:79]
    ds_read_b128 v[140:143], v45 offset:40960
    ds_read_b128 v[144:147], v46 offset:40960
    ds_read_b128 v[148:151], v47 offset:40960
    v_mfma_f32_16x16x32_bf16 v[80:83], v[152:155], v[128:131], v[80:83]
    ds_read_b64_tr_b16 v[168:169], v62 offset:40960
    ds_read_b64_tr_b16 v[170:171], v62 offset:41472
    ds_read_b64_tr_b16 v[172:173], v66 offset:40960
    v_mfma_f32_16x16x32_bf16 v[84:87], v[152:155], v[132:135], v[84:87]
    ds_read_b64_tr_b16 v[174:175], v66 offset:41472
    v_mov_b32 v34, v32
    s_nop 1
    v_permlane32_swap_b32 v32, v34
    v_mfma_f32_16x16x32_bf16 v[88:91], v[156:159], v[120:123], v[88:91]
    v_mov_b32 v30, v36
    s_nop 1
    v_permlane32_swap_b32 v36, v30
    v_add_f32 v36, v36, v30
    v_mfma_f32_16x16x32_bf16 v[92:95], v[156:159], v[124:127], v[92:95]
    v_mov_b32 v30, v36
    s_nop 1
    v_permlane16_swap_b32 v36, v30
    v_add_f32 v36, v36, v30
    v_mfma_f32_16x16x32_bf16 v[96:99], v[156:159], v[128:131], v[96:99]
    v_mul_f32 v32, 0x3b000000, v32
    v_mul_f32 v28, v32, v32
    v_mul_f32 v34, 0x3b000000, v34
    v_mfma_f32_16x16x32_bf16 v[100:103], v[156:159], v[132:135], v[100:103]
    v_sub_f32 v34, v34, v28
    v_max_f32 v34, 0, v34
    v_add_f32 v34, 0x3727c5ac, v34
    v_mfma_f32_16x16x32_bf16 v[104:107], v[120:123], v[160:163], v[104:107]
    v_mul_f32 v36, 0xbfb8aa3b, v36
    v_rsq_f32 v28, v34
    v_exp_f32 v36, v36
    v_mfma_f32_16x16x32_bf16 v[108:111], v[124:127], v[160:163], v[108:111]
    v_mov_b32 v31, 0
    v_mul_f32 v29, v28, v32
    v_add_f32 v36, 1.0, v36
    v_mfma_f32_16x16x32_bf16 v[112:115], v[128:131], v[160:163], v[112:115]
    v_rcp_f32 v30, v36
    v_mov_b32 v33, s101
    v_mfma_f32_16x16x32_bf16 v[116:119], v[132:135], v[160:163], v[116:119]
    s_mov_b64 s[6:7], exec
    s_mov_b64 exec, 1
    buffer_store_dwordx4 v[28:31], v33, s[16:19], 0 offen sc1
    s_mov_b64 exec, s[6:7]
    s_waitcnt vmcnt(10) lgkmcnt(0)
    s_barrier
    s_nop 1
    v_mfma_f32_16x16x32_bf16 v[72:75], v[164:167], v[136:139], v[72:75]
    ds_read_b64_tr_b16 v[152:153], v57 offset:0
    ds_read_b64_tr_b16 v[154:155], v57 offset:512
    ds_read_b128 v[120:123], v48 offset:0
    v_mfma_f32_16x16x32_bf16 v[76:79], v[164:167], v[140:143], v[76:79]
    ds_read_b128 v[124:127], v49 offset:0
    ds_read_b128 v[128:131], v50 offset:0
    ds_read_b128 v[132:135], v51 offset:0
    v_mfma_f32_16x16x32_bf16 v[80:83], v[164:167], v[144:147], v[80:83]
    ds_read_b64_tr_b16 v[156:157], v61 offset:0
    ds_read_b64_tr_b16 v[158:159], v61 offset:512
    ds_read_b64_tr_b16 v[160:161], v65 offset:0
    v_mfma_f32_16x16x32_bf16 v[84:87], v[164:167], v[148:151], v[84:87]
    ds_read_b64_tr_b16 v[162:163], v65 offset:512
    s_add_u32 s48, s1, 5
    s_and_b32 s48, s48, 7
    v_mfma_f32_16x16x32_bf16 v[88:91], v[168:171], v[136:139], v[88:91]
    s_lshl_b32 s49, s48, 7
    s_mul_i32 s48, s48, 196608
    s_add_u32 m0, s37, 40960
    v_mfma_f32_16x16x32_bf16 v[92:95], v[168:171], v[140:143], v[92:95]
    buffer_load_dwordx4 v10, s[8:11], s49 offen lds
    s_add_u32 m0, s37, 41984
    s_add_u32 s49, s49, 8192
    v_mfma_f32_16x16x32_bf16 v[96:99], v[168:171], v[144:147], v[96:99]
    buffer_load_dwordx4 v10, s[8:11], s49 offen lds
    s_add_u32 m0, s38, 40960
    s_add_u32 s39, s34, s48
    v_mfma_f32_16x16x32_bf16 v[100:103], v[168:171], v[148:151], v[100:103]
    buffer_load_dwordx4 v11, s[12:15], s39 offen lds
    s_add_u32 m0, s38, 49152
    s_add_u32 s39, s35, s48
    v_mfma_f32_16x16x32_bf16 v[104:107], v[136:139], v[172:175], v[104:107]
    buffer_load_dwordx4 v11, s[12:15], s39 offen lds
    s_add_u32 m0, s38, 57344
    s_add_u32 s39, s36, s48
    v_mfma_f32_16x16x32_bf16 v[108:111], v[140:143], v[172:175], v[108:111]
    buffer_load_dwordx4 v11, s[12:15], s39 offen lds
    s_mov_b32 s6, 1409024
    s_movk_i32 s3, 5504
    v_mfma_f32_16x16x32_bf16 v[112:115], v[144:147], v[172:175], v[112:115]
    s_cmp_ge_u32 s30, 6
    s_cselect_b32 s4, s46, s54
    s_cselect_b32 s5, s47, s55
    v_mfma_f32_16x16x32_bf16 v[116:119], v[148:151], v[172:175], v[116:119]
    s_cselect_b32 s6, 524288, s6
    s_mov_b32 s7, 0x00020000
    s_cselect_b32 s3, 2048, s3
    s_mul_i32 s3, s3, s2
    s_cselect_b32 s100, 6144, 0
    s_sub_u32 s3, s3, s100
    v_lshl_add_u32 v7, v0, 4, s3
    buffer_load_dwordx4 v[208:211], v7, s[4:7], 0 offen
    s_waitcnt lgkmcnt(0)
    v_mfma_f32_16x16x32_bf16 v[72:75], v[152:155], v[120:123], v[72:75]
    ds_read_b64_tr_b16 v[164:165], v59 offset:0
    ds_read_b64_tr_b16 v[166:167], v59 offset:512
    v_mfma_f32_16x16x32_bf16 v[76:79], v[152:155], v[124:127], v[76:79]
    ds_read_b128 v[136:139], v52 offset:0
    ds_read_b128 v[140:143], v53 offset:0
    v_mfma_f32_16x16x32_bf16 v[80:83], v[152:155], v[128:131], v[80:83]
    ds_read_b128 v[144:147], v54 offset:0
    ds_read_b128 v[148:151], v55 offset:0
    v_mfma_f32_16x16x32_bf16 v[84:87], v[152:155], v[132:135], v[84:87]
    ds_read_b64_tr_b16 v[168:169], v63 offset:0
    ds_read_b64_tr_b16 v[170:171], v63 offset:512
    v_mfma_f32_16x16x32_bf16 v[88:91], v[156:159], v[120:123], v[88:91]
    ds_read_b64_tr_b16 v[172:173], v67 offset:0
    ds_read_b64_tr_b16 v[174:175], v67 offset:512
    v_mfma_f32_16x16x32_bf16 v[92:95], v[156:159], v[124:127], v[92:95]
    v_mfma_f32_16x16x32_bf16 v[96:99], v[156:159], v[128:131], v[96:99]
    v_mfma_f32_16x16x32_bf16 v[100:103], v[156:159], v[132:135], v[100:103]
    v_mfma_f32_16x16x32_bf16 v[104:107], v[120:123], v[160:163], v[104:107]
    v_mfma_f32_16x16x32_bf16 v[108:111], v[124:127], v[160:163], v[108:111]
    v_mfma_f32_16x16x32_bf16 v[112:115], v[128:131], v[160:163], v[112:115]
    v_mfma_f32_16x16x32_bf16 v[116:119], v[132:135], v[160:163], v[116:119]
    s_waitcnt vmcnt(11) lgkmcnt(0)
    s_barrier
    v_mfma_f32_16x16x32_bf16 v[72:75], v[164:167], v[136:139], v[72:75]
    ds_read_b64_tr_b16 v[152:153], v57 offset:40960
    ds_read_b64_tr_b16 v[154:155], v57 offset:41472
    ds_read_b128 v[120:123], v48 offset:40960
    v_mfma_f32_16x16x32_bf16 v[76:79], v[164:167], v[140:143], v[76:79]
    ds_read_b128 v[124:127], v49 offset:40960
    ds_read_b128 v[128:131], v50 offset:40960
    ds_read_b128 v[132:135], v51 offset:40960
    v_mfma_f32_16x16x32_bf16 v[80:83], v[164:167], v[144:147], v[80:83]
    ds_read_b64_tr_b16 v[156:157], v61 offset:40960
    ds_read_b64_tr_b16 v[158:159], v61 offset:41472
    ds_read_b64_tr_b16 v[160:161], v65 offset:40960
    v_mfma_f32_16x16x32_bf16 v[84:87], v[164:167], v[148:151], v[84:87]
    ds_read_b64_tr_b16 v[162:163], v65 offset:41472
    s_add_u32 s48, s1, 6
    s_and_b32 s48, s48, 7
    v_mfma_f32_16x16x32_bf16 v[88:91], v[168:171], v[136:139], v[88:91]
    s_lshl_b32 s49, s48, 7
    s_mul_i32 s48, s48, 196608
    s_add_u32 m0, s37, 81920
    v_mfma_f32_16x16x32_bf16 v[92:95], v[168:171], v[140:143], v[92:95]
    buffer_load_dwordx4 v10, s[8:11], s49 offen lds
    s_add_u32 m0, s37, 82944
    s_add_u32 s49, s49, 8192
    v_mfma_f32_16x16x32_bf16 v[96:99], v[168:171], v[144:147], v[96:99]
    buffer_load_dwordx4 v10, s[8:11], s49 offen lds
    s_add_u32 m0, s38, 81920
    s_add_u32 s39, s34, s48
    v_mfma_f32_16x16x32_bf16 v[100:103], v[168:171], v[148:151], v[100:103]
    buffer_load_dwordx4 v11, s[12:15], s39 offen lds
    s_add_u32 m0, s38, 90112
    s_add_u32 s39, s35, s48
    v_mfma_f32_16x16x32_bf16 v[104:107], v[136:139], v[172:175], v[104:107]
    buffer_load_dwordx4 v11, s[12:15], s39 offen lds
    s_add_u32 m0, s38, 98304
    s_add_u32 s39, s36, s48
    v_mfma_f32_16x16x32_bf16 v[108:111], v[140:143], v[172:175], v[108:111]
    buffer_load_dwordx4 v11, s[12:15], s39 offen lds
    v_mfma_f32_16x16x32_bf16 v[112:115], v[144:147], v[172:175], v[112:115]
    v_mfma_f32_16x16x32_bf16 v[116:119], v[148:151], v[172:175], v[116:119]
    s_waitcnt lgkmcnt(0)
    v_mfma_f32_16x16x32_bf16 v[72:75], v[152:155], v[120:123], v[72:75]
    ds_read_b64_tr_b16 v[164:165], v59 offset:40960
    ds_read_b64_tr_b16 v[166:167], v59 offset:41472
    v_mfma_f32_16x16x32_bf16 v[76:79], v[152:155], v[124:127], v[76:79]
    ds_read_b128 v[136:139], v52 offset:40960
    ds_read_b128 v[140:143], v53 offset:40960
    v_mfma_f32_16x16x32_bf16 v[80:83], v[152:155], v[128:131], v[80:83]
    ds_read_b128 v[144:147], v54 offset:40960
    ds_read_b128 v[148:151], v55 offset:40960
    v_mfma_f32_16x16x32_bf16 v[84:87], v[152:155], v[132:135], v[84:87]
    ds_read_b64_tr_b16 v[168:169], v63 offset:40960
    ds_read_b64_tr_b16 v[170:171], v63 offset:41472
    v_mfma_f32_16x16x32_bf16 v[88:91], v[156:159], v[120:123], v[88:91]
    ds_read_b64_tr_b16 v[172:173], v67 offset:40960
    ds_read_b64_tr_b16 v[174:175], v67 offset:41472
    v_mfma_f32_16x16x32_bf16 v[92:95], v[156:159], v[124:127], v[92:95]
    v_mfma_f32_16x16x32_bf16 v[96:99], v[156:159], v[128:131], v[96:99]
    v_mfma_f32_16x16x32_bf16 v[100:103], v[156:159], v[132:135], v[100:103]
    v_mfma_f32_16x16x32_bf16 v[104:107], v[120:123], v[160:163], v[104:107]
    v_mfma_f32_16x16x32_bf16 v[108:111], v[124:127], v[160:163], v[108:111]
    v_mfma_f32_16x16x32_bf16 v[112:115], v[128:131], v[160:163], v[112:115]
    v_mfma_f32_16x16x32_bf16 v[116:119], v[132:135], v[160:163], v[116:119]
    s_cmp_lg_u32 s30, 7
    s_cbranch_scc1 F_GOK0
    v_and_b32 v7, 7, v2
    v_lshlrev_b32 v7, 2, v7
    buffer_load_dword v8, v7, s[96:99], 0 offen offset:32
    s_waitcnt vmcnt(0)
    v_cmp_eq_u32 vcc, 1, v8
    s_nop 2
    s_cmp_eq_u64 vcc, -1
    s_cbranch_scc1 F_GOK0
    s_mov_b32 s4, 0
F_GSP0:
    buffer_load_dword v8, v7, s[96:99], 0 offen offset:32 sc0 sc1
    s_waitcnt vmcnt(0)
    v_cmp_eq_u32 vcc, 1, v8
    s_nop 2
    s_cmp_eq_u64 vcc, -1
    s_cbranch_scc1 F_GOK0
    s_add_u32 s4, s4, 1
    s_cmp_ge_u32 s4, 60000
    s_cbranch_scc1 F_GOK0
    s_sleep 8
    s_branch F_GSP0
F_GOK0:
    s_waitcnt vmcnt(11) lgkmcnt(0)
    s_barrier
    s_cmp_lg_u32 s30, 7
    s_cbranch_scc1 F_NOPRF0
    s_lshl_b32 s3, s28, 7
    s_lshl_b32 s4, s29, 2
    s_add_u32 s3, s3, s4
    s_add_u32 s3, s3, 13113344
    v_mov_b32 v7, s3
    v_mov_b32 v8, s0
    s_mov_b64 s[6:7], exec
    s_mov_b64 exec, 1
    buffer_store_dword v8, v7, s[16:19], 0 offen sc1
    s_lshl_b32 s3, s29, 7
    s_lshl_b32 s4, s28, 2
    s_add_u32 s3, s3, s4
    s_add_u32 s3, s3, 13111296
    v_mov_b32 v7, s3
    buffer_store_dword v8, v7, s[16:19], 0 offen sc1
    s_mov_b64 exec, s[6:7]
F_NOPRF0:
    s_nop 3
    v_mfma_f32_16x16x32_bf16 v[72:75], v[164:167], v[136:139], v[72:75]
    ds_read_b64_tr_b16 v[152:153], v56 offset:0
    ds_read_b64_tr_b16 v[154:155], v56 offset:512
    ds_read_b128 v[120:123], v40 offset:0
    v_mfma_f32_16x16x32_bf16 v[76:79], v[164:167], v[140:143], v[76:79]
    ds_read_b128 v[124:127], v41 offset:0
    ds_read_b128 v[128:131], v42 offset:0
    ds_read_b128 v[132:135], v43 offset:0
    v_mfma_f32_16x16x32_bf16 v[80:83], v[164:167], v[144:147], v[80:83]
    ds_read_b64_tr_b16 v[156:157], v60 offset:0
    ds_read_b64_tr_b16 v[158:159], v60 offset:512
    ds_read_b64_tr_b16 v[160:161], v64 offset:0
    v_mfma_f32_16x16x32_bf16 v[84:87], v[164:167], v[148:151], v[84:87]
    ds_read_b64_tr_b16 v[162:163], v64 offset:512
    s_add_u32 s48, s1, 7
    s_and_b32 s48, s48, 7
    v_mfma_f32_16x16x32_bf16 v[88:91], v[168:171], v[136:139], v[88:91]
    s_lshl_b32 s49, s48, 7
    s_mul_i32 s48, s48, 196608
    s_add_u32 m0, s37, 122880
    v_mfma_f32_16x16x32_bf16 v[92:95], v[168:171], v[140:143], v[92:95]
    buffer_load_dwordx4 v10, s[8:11], s49 offen lds
    s_add_u32 m0, s37, 123904
    s_add_u32 s49, s49, 8192
    v_mfma_f32_16x16x32_bf16 v[96:99], v[168:171], v[144:147], v[96:99]
    buffer_load_dwordx4 v10, s[8:11], s49 offen lds
    s_add_u32 m0, s38, 122880
    s_add_u32 s39, s34, s48
    v_mfma_f32_16x16x32_bf16 v[100:103], v[168:171], v[148:151], v[100:103]
    buffer_load_dwordx4 v11, s[12:15], s39 offen lds
    s_add_u32 m0, s38, 131072
    s_add_u32 s39, s35, s48
    v_mfma_f32_16x16x32_bf16 v[104:107], v[136:139], v[172:175], v[104:107]
    buffer_load_dwordx4 v11, s[12:15], s39 offen lds
    s_add_u32 m0, s38, 139264
    s_add_u32 s39, s36, s48
    v_mfma_f32_16x16x32_bf16 v[108:111], v[140:143], v[172:175], v[108:111]
    buffer_load_dwordx4 v11, s[12:15], s39 offen lds
    v_mfma_f32_16x16x32_bf16 v[112:115], v[144:147], v[172:175], v[112:115]
    v_mfma_f32_16x16x32_bf16 v[116:119], v[148:151], v[172:175], v[116:119]
    s_waitcnt lgkmcnt(0)
    v_mfma_f32_16x16x32_bf16 v[72:75], v[152:155], v[120:123], v[72:75]
    ds_read_b64_tr_b16 v[164:165], v58 offset:0
    ds_read_b64_tr_b16 v[166:167], v58 offset:512
    v_mfma_f32_16x16x32_bf16 v[76:79], v[152:155], v[124:127], v[76:79]
    ds_read_b128 v[136:139], v44 offset:0
    ds_read_b128 v[140:143], v45 offset:0
    v_mfma_f32_16x16x32_bf16 v[80:83], v[152:155], v[128:131], v[80:83]
    ds_read_b128 v[144:147], v46 offset:0
    ds_read_b128 v[148:151], v47 offset:0
    v_mfma_f32_16x16x32_bf16 v[84:87], v[152:155], v[132:135], v[84:87]
    ds_read_b64_tr_b16 v[168:169], v62 offset:0
    ds_read_b64_tr_b16 v[170:171], v62 offset:512
    v_mfma_f32_16x16x32_bf16 v[88:91], v[156:159], v[120:123], v[88:91]
    ds_read_b64_tr_b16 v[172:173], v66 offset:0
    ds_read_b64_tr_b16 v[174:175], v66 offset:512
    v_mfma_f32_16x16x32_bf16 v[92:95], v[156:159], v[124:127], v[92:95]
    v_mfma_f32_16x16x32_bf16 v[96:99], v[156:159], v[128:131], v[96:99]
    v_mfma_f32_16x16x32_bf16 v[100:103], v[156:159], v[132:135], v[100:103]
    v_mfma_f32_16x16x32_bf16 v[104:107], v[120:123], v[160:163], v[104:107]
    v_mfma_f32_16x16x32_bf16 v[108:111], v[124:127], v[160:163], v[108:111]
    v_mfma_f32_16x16x32_bf16 v[112:115], v[128:131], v[160:163], v[112:115]
    v_mfma_f32_16x16x32_bf16 v[116:119], v[132:135], v[160:163], v[116:119]
    s_waitcnt vmcnt(11) lgkmcnt(0)
    s_barrier
    v_mfma_f32_16x16x32_bf16 v[72:75], v[164:167], v[136:139], v[72:75]
    ds_read_b64_tr_b16 v[152:153], v56 offset:40960
    ds_read_b64_tr_b16 v[154:155], v56 offset:41472
    ds_read_b128 v[120:123], v40 offset:40960
    v_mfma_f32_16x16x32_bf16 v[76:79], v[164:167], v[140:143], v[76:79]
    ds_read_b128 v[124:127], v41 offset:40960
    ds_read_b128 v[128:131], v42 offset:40960
    ds_read_b128 v[132:135], v43 offset:40960
    v_mfma_f32_16x16x32_bf16 v[80:83], v[164:167], v[144:147], v[80:83]
    ds_read_b64_tr_b16 v[156:157], v60 offset:40960
    ds_read_b64_tr_b16 v[158:159], v60 offset:41472
    ds_read_b64_tr_b16 v[160:161], v64 offset:40960
    v_mfma_f32_16x16x32_bf16 v[84:87], v[164:167], v[148:151], v[84:87]
    ds_read_b64_tr_b16 v[162:163], v64 offset:41472
    s_mov_b32 s8, s54
    s_mov_b32 s9, s55
    v_mfma_f32_16x16x32_bf16 v[88:91], v[168:171], v[136:139], v[88:91]
    s_mov_b32 s10, 1409024
    s_mov_b32 s11, 0x00020000
    s_mov_b32 s12, s46
    v_mfma_f32_16x16x32_bf16 v[92:95], v[168:171], v[140:143], v[92:95]
    s_mov_b32 s13, s47
    s_mov_b32 s14, 524288
    s_mov_b32 s15, 0x00020000
    v_mfma_f32_16x16x32_bf16 v[96:99], v[168:171], v[144:147], v[96:99]
    s_lshl_b32 s34, s30, 12
    s_lshr_b32 s35, s30, 1
    s_mul_i32 s35, s35, 40960
    v_mfma_f32_16x16x32_bf16 v[100:103], v[168:171], v[148:151], v[100:103]
    s_and_b32 s36, s30, 1
    s_lshl_b32 s36, s36, 12
    s_add_u32 s35, s35, s36
    v_mfma_f32_16x16x32_bf16 v[104:107], v[136:139], v[172:175], v[104:107]
    s_add_u32 s35, s35, 32768
    s_mul_i32 s36, s30, 49152
    s_lshl_b32 s38, s30, 16
    v_mfma_f32_16x16x32_bf16 v[108:111], v[140:143], v[172:175], v[108:111]
    s_add_u32 m0, s34, 0
    s_add_u32 s39, s38, 0
    buffer_load_dwordx4 v12, s[12:15], s39 offen lds
    v_mfma_f32_16x16x32_bf16 v[112:115], v[144:147], v[172:175], v[112:115]
    s_add_u32 m0, s34, 1024
    s_add_u32 s39, s38, 8192
    buffer_load_dwordx4 v12, s[12:15], s39 offen lds
    v_mfma_f32_16x16x32_bf16 v[116:119], v[148:151], v[172:175], v[116:119]
    s_add_u32 m0, s34, 2048
    s_add_u32 s39, s38, 16384
    buffer_load_dwordx4 v12, s[12:15], s39 offen lds
    s_add_u32 m0, s34, 3072
    s_add_u32 s39, s38, 24576
    buffer_load_dwordx4 v12, s[12:15], s39 offen lds
    s_waitcnt lgkmcnt(0)
    v_mfma_f32_16x16x32_bf16 v[72:75], v[152:155], v[120:123], v[72:75]
    ds_read_b64_tr_b16 v[164:165], v58 offset:40960
    ds_read_b64_tr_b16 v[166:167], v58 offset:41472
    v_mfma_f32_16x16x32_bf16 v[76:79], v[152:155], v[124:127], v[76:79]
    ds_read_b128 v[136:139], v44 offset:40960
    ds_read_b128 v[140:143], v45 offset:40960
    v_mfma_f32_16x16x32_bf16 v[80:83], v[152:155], v[128:131], v[80:83]
    ds_read_b128 v[144:147], v46 offset:40960
    ds_read_b128 v[148:151], v47 offset:40960
    v_mfma_f32_16x16x32_bf16 v[84:87], v[152:155], v[132:135], v[84:87]
    ds_read_b64_tr_b16 v[168:169], v62 offset:40960
    ds_read_b64_tr_b16 v[170:171], v62 offset:41472
    v_mfma_f32_16x16x32_bf16 v[88:91], v[156:159], v[120:123], v[88:91]
    ds_read_b64_tr_b16 v[172:173], v66 offset:40960
    ds_read_b64_tr_b16 v[174:175], v66 offset:41472
    v_mfma_f32_16x16x32_bf16 v[92:95], v[156:159], v[124:127], v[92:95]
    v_mfma_f32_16x16x32_bf16 v[96:99], v[156:159], v[128:131], v[96:99]
    v_mfma_f32_16x16x32_bf16 v[100:103], v[156:159], v[132:135], v[100:103]
    v_mfma_f32_16x16x32_bf16 v[104:107], v[120:123], v[160:163], v[104:107]
    v_mfma_f32_16x16x32_bf16 v[108:111], v[124:127], v[160:163], v[108:111]
    v_mfma_f32_16x16x32_bf16 v[112:115], v[128:131], v[160:163], v[112:115]
    v_mfma_f32_16x16x32_bf16 v[116:119], v[132:135], v[160:163], v[116:119]
    s_waitcnt vmcnt(9) lgkmcnt(0)
    s_barrier
    v_mfma_f32_16x16x32_bf16 v[72:75], v[164:167], v[136:139], v[72:75]
    ds_read_b64_tr_b16 v[152:153], v57 offset:0
    ds_read_b64_tr_b16 v[154:155], v57 offset:512
    ds_read_b128 v[120:123], v48 offset:0
    v_mfma_f32_16x16x32_bf16 v[76:79], v[164:167], v[140:143], v[76:79]
    ds_read_b128 v[124:127], v49 offset:0
    ds_read_b128 v[128:131], v50 offset:0
    ds_read_b128 v[132:135], v51 offset:0
    v_mfma_f32_16x16x32_bf16 v[80:83], v[164:167], v[144:147], v[80:83]
    ds_read_b64_tr_b16 v[156:157], v61 offset:0
    ds_read_b64_tr_b16 v[158:159], v61 offset:512
    ds_read_b64_tr_b16 v[160:161], v65 offset:0
    v_mfma_f32_16x16x32_bf16 v[84:87], v[164:167], v[148:151], v[84:87]
    ds_read_b64_tr_b16 v[162:163], v65 offset:512
    s_add_u32 m0, s34, 40960
    s_add_u32 s39, s38, 32768
    v_mfma_f32_16x16x32_bf16 v[88:91], v[168:171], v[136:139], v[88:91]
    buffer_load_dwordx4 v12, s[12:15], s39 offen lds
    s_add_u32 m0, s34, 41984
    s_add_u32 s39, s38, 40960
    v_mfma_f32_16x16x32_bf16 v[92:95], v[168:171], v[140:143], v[92:95]
    buffer_load_dwordx4 v12, s[12:15], s39 offen lds
    s_add_u32 m0, s34, 43008
    s_add_u32 s39, s38, 49152
    v_mfma_f32_16x16x32_bf16 v[96:99], v[168:171], v[144:147], v[96:99]
    buffer_load_dwordx4 v12, s[12:15], s39 offen lds
    s_add_u32 m0, s34, 44032
    s_add_u32 s39, s38, 57344
    v_mfma_f32_16x16x32_bf16 v[100:103], v[168:171], v[148:151], v[100:103]
    buffer_load_dwordx4 v12, s[12:15], s39 offen lds
    v_mfma_f32_16x16x32_bf16 v[104:107], v[136:139], v[172:175], v[104:107]
    v_mfma_f32_16x16x32_bf16 v[108:111], v[140:143], v[172:175], v[108:111]
    v_mfma_f32_16x16x32_bf16 v[112:115], v[144:147], v[172:175], v[112:115]
    v_mfma_f32_16x16x32_bf16 v[116:119], v[148:151], v[172:175], v[116:119]
    s_waitcnt lgkmcnt(0)
    v_mfma_f32_16x16x32_bf16 v[72:75], v[152:155], v[120:123], v[72:75]
    ds_read_b64_tr_b16 v[164:165], v59 offset:0
    ds_read_b64_tr_b16 v[166:167], v59 offset:512
    v_mfma_f32_16x16x32_bf16 v[76:79], v[152:155], v[124:127], v[76:79]
    ds_read_b128 v[136:139], v52 offset:0
    ds_read_b128 v[140:143], v53 offset:0
    v_mfma_f32_16x16x32_bf16 v[80:83], v[152:155], v[128:131], v[80:83]
    ds_read_b128 v[144:147], v54 offset:0
    ds_read_b128 v[148:151], v55 offset:0
    v_mfma_f32_16x16x32_bf16 v[84:87], v[152:155], v[132:135], v[84:87]
    ds_read_b64_tr_b16 v[168:169], v63 offset:0
    ds_read_b64_tr_b16 v[170:171], v63 offset:512
    v_mfma_f32_16x16x32_bf16 v[88:91], v[156:159], v[120:123], v[88:91]
    ds_read_b64_tr_b16 v[172:173], v67 offset:0
    ds_read_b64_tr_b16 v[174:175], v67 offset:512
    v_mfma_f32_16x16x32_bf16 v[92:95], v[156:159], v[124:127], v[92:95]
    v_mfma_f32_16x16x32_bf16 v[96:99], v[156:159], v[128:131], v[96:99]
    v_mfma_f32_16x16x32_bf16 v[100:103], v[156:159], v[132:135], v[100:103]
    v_mfma_f32_16x16x32_bf16 v[104:107], v[120:123], v[160:163], v[104:107]
    v_mfma_f32_16x16x32_bf16 v[108:111], v[124:127], v[160:163], v[108:111]
    v_mfma_f32_16x16x32_bf16 v[112:115], v[128:131], v[160:163], v[112:115]
    v_mfma_f32_16x16x32_bf16 v[116:119], v[132:135], v[160:163], v[116:119]
    s_waitcnt vmcnt(8) lgkmcnt(0)
    s_barrier
    v_mfma_f32_16x16x32_bf16 v[72:75], v[164:167], v[136:139], v[72:75]
    ds_read_b64_tr_b16 v[152:153], v57 offset:40960
    ds_read_b64_tr_b16 v[154:155], v57 offset:41472
    ds_read_b128 v[120:123], v48 offset:40960
    v_mfma_f32_16x16x32_bf16 v[76:79], v[164:167], v[140:143], v[76:79]
    ds_read_b128 v[124:127], v49 offset:40960
    ds_read_b128 v[128:131], v50 offset:40960
    ds_read_b128 v[132:135], v51 offset:40960
    v_mfma_f32_16x16x32_bf16 v[80:83], v[164:167], v[144:147], v[80:83]
    ds_read_b64_tr_b16 v[156:157], v61 offset:40960
    ds_read_b64_tr_b16 v[158:159], v61 offset:41472
    ds_read_b64_tr_b16 v[160:161], v65 offset:40960
    v_mfma_f32_16x16x32_bf16 v[84:87], v[164:167], v[148:151], v[84:87]
    ds_read_b64_tr_b16 v[162:163], v65 offset:41472
    s_add_u32 m0, s34, 81920
    s_add_u32 s39, s36, 1032192
    v_mfma_f32_16x16x32_bf16 v[88:91], v[168:171], v[136:139], v[88:91]
    buffer_load_dwordx4 v12, s[8:11], s39 offen lds
    s_add_u32 m0, s34, 82944
    s_add_u32 s39, s36, 1040384
    v_mfma_f32_16x16x32_bf16 v[92:95], v[168:171], v[140:143], v[92:95]
    buffer_load_dwordx4 v12, s[8:11], s39 offen lds
    s_add_u32 m0, s34, 83968
    s_add_u32 s39, s36, 1048576
    v_mfma_f32_16x16x32_bf16 v[96:99], v[168:171], v[144:147], v[96:99]
    buffer_load_dwordx4 v12, s[8:11], s39 offen lds
    s_add_u32 m0, s34, 84992
    s_add_u32 s39, s36, 1056768
    v_mfma_f32_16x16x32_bf16 v[100:103], v[168:171], v[148:151], v[100:103]
    buffer_load_dwordx4 v12, s[8:11], s39 offen lds
    v_mfma_f32_16x16x32_bf16 v[104:107], v[136:139], v[172:175], v[104:107]
    v_mfma_f32_16x16x32_bf16 v[108:111], v[140:143], v[172:175], v[108:111]
    v_mfma_f32_16x16x32_bf16 v[112:115], v[144:147], v[172:175], v[112:115]
    v_mfma_f32_16x16x32_bf16 v[116:119], v[148:151], v[172:175], v[116:119]
    s_waitcnt lgkmcnt(0)
    v_mfma_f32_16x16x32_bf16 v[72:75], v[152:155], v[120:123], v[72:75]
    ds_read_b64_tr_b16 v[164:165], v59 offset:40960
    ds_read_b64_tr_b16 v[166:167], v59 offset:41472
    v_mfma_f32_16x16x32_bf16 v[76:79], v[152:155], v[124:127], v[76:79]
    ds_read_b128 v[136:139], v52 offset:40960
    ds_read_b128 v[140:143], v53 offset:40960
    v_mfma_f32_16x16x32_bf16 v[80:83], v[152:155], v[128:131], v[80:83]
    ds_read_b128 v[144:147], v54 offset:40960
    ds_read_b128 v[148:151], v55 offset:40960
    v_mfma_f32_16x16x32_bf16 v[84:87], v[152:155], v[132:135], v[84:87]
    ds_read_b64_tr_b16 v[168:169], v63 offset:40960
    ds_read_b64_tr_b16 v[170:171], v63 offset:41472
    v_mfma_f32_16x16x32_bf16 v[88:91], v[156:159], v[120:123], v[88:91]
    ds_read_b64_tr_b16 v[172:173], v67 offset:40960
    ds_read_b64_tr_b16 v[174:175], v67 offset:41472
    v_mfma_f32_16x16x32_bf16 v[92:95], v[156:159], v[124:127], v[92:95]
    v_mfma_f32_16x16x32_bf16 v[96:99], v[156:159], v[128:131], v[96:99]
    v_mfma_f32_16x16x32_bf16 v[100:103], v[156:159], v[132:135], v[100:103]
    v_mfma_f32_16x16x32_bf16 v[104:107], v[120:123], v[160:163], v[104:107]
    v_mfma_f32_16x16x32_bf16 v[108:111], v[124:127], v[160:163], v[108:111]
    v_mfma_f32_16x16x32_bf16 v[112:115], v[128:131], v[160:163], v[112:115]
    v_mfma_f32_16x16x32_bf16 v[116:119], v[132:135], v[160:163], v[116:119]
    s_cmp_lg_u32 s30, 7
    s_cbranch_scc1 F_POK0
    s_lshl_b32 s3, s29, 7
    s_add_u32 s3, s3, 13111296
    v_lshl_add_u32 v7, v3, 2, s3
    buffer_load_dword v8, v7, s[16:19], 0 offen
    s_waitcnt vmcnt(0)
    v_cmp_ne_u32 vcc, 0, v8
    s_nop 2
    s_cmp_eq_u64 vcc, -1
    s_cbranch_scc1 F_POK0
    s_mov_b32 s4, 0
F_PSP0:
    buffer_load_dword v8, v7, s[16:19], 0 offen sc0 sc1
    s_waitcnt vmcnt(0)
    v_cmp_ne_u32 vcc, 0, v8
    s_nop 2
    s_cmp_eq_u64 vcc, -1
    s_cbranch_scc1 F_POK0
    s_add_u32 s4, s4, 1
    s_cmp_ge_u32 s4, 60000
    s_cbranch_scc1 F_POK0
    s_sleep 4
    s_branch F_PSP0
F_POK0:
    s_waitcnt lgkmcnt(0)
    s_barrier
    v_mfma_f32_16x16x32_bf16 v[72:75], v[164:167], v[136:139], v[72:75]
    v_mfma_f32_16x16x32_bf16 v[76:79], v[164:167], v[140:143], v[76:79]
    v_mfma_f32_16x16x32_bf16 v[80:83], v[164:167], v[144:147], v[80:83]
    v_mfma_f32_16x16x32_bf16 v[84:87], v[164:167], v[148:151], v[84:87]
    v_mfma_f32_16x16x32_bf16 v[88:91], v[168:171], v[136:139], v[88:91]
    v_mfma_f32_16x16x32_bf16 v[92:95], v[168:171], v[140:143], v[92:95]
    v_mfma_f32_16x16x32_bf16 v[96:99], v[168:171], v[144:147], v[96:99]
    v_mfma_f32_16x16x32_bf16 v[100:103], v[168:171], v[148:151], v[100:103]
    v_mfma_f32_16x16x32_bf16 v[104:107], v[136:139], v[172:175], v[104:107]
    v_mfma_f32_16x16x32_bf16 v[108:111], v[140:143], v[172:175], v[108:111]
    v_mfma_f32_16x16x32_bf16 v[112:115], v[144:147], v[172:175], v[112:115]
    v_mfma_f32_16x16x32_bf16 v[116:119], v[148:151], v[172:175], v[116:119]
    s_cmp_eq_u32 s30, 7
    s_cbranch_scc1 F_NOP7X0
    s_add_u32 m0, s34, 122880
    s_add_u32 s39, s36, 0
    buffer_load_dwordx4 v12, s[8:11], s39 offen lds
    s_add_u32 m0, s34, 123904
    s_add_u32 s39, s36, 8192
    buffer_load_dwordx4 v12, s[8:11], s39 offen lds
    s_add_u32 m0, s34, 124928
    s_add_u32 s39, s36, 16384
    buffer_load_dwordx4 v12, s[8:11], s39 offen lds
    s_add_u32 m0, s34, 125952
    s_add_u32 s39, s36, 24576
    buffer_load_dwordx4 v12, s[8:11], s39 offen lds
    s_add_u32 m0, s35, 0
    s_add_u32 s39, s36, 32768
    buffer_load_dwordx4 v12, s[8:11], s39 offen lds
    s_add_u32 m0, s35, 1024
    s_add_u32 s39, s36, 40960
    buffer_load_dwordx4 v12, s[8:11], s39 offen lds
    s_add_u32 m0, s35, 2048
    s_add_u32 s39, s36, 1064960
    buffer_load_dwordx4 v12, s[8:11], s39 offen lds
    s_add_u32 m0, s35, 3072
    s_add_u32 s39, s36, 1073152
    buffer_load_dwordx4 v12, s[8:11], s39 offen lds
F_NOP7X0:
    v_lshrrev_b32 v7, 2, v3
    v_lshl_add_u32 v7, v4, 2, v7
    v_lshrrev_b32 v8, 1, v7
    v_and_b32 v8, 3, v8
    v_and_b32 v9, 3, v3
    v_lshlrev_b32 v9, 3, v9
    v_lshl_add_u32 v9, v7, 7, v9
    v_add_u32 v9, s34, v9
    v_xor_b32 v7, 0, v8
    v_lshl_add_u32 v176, v7, 5, v9
    v_xor_b32 v7, 1, v8
    v_lshl_add_u32 v177, v7, 5, v9
    v_xor_b32 v7, 2, v8
    v_lshl_add_u32 v178, v7, 5, v9
    v_xor_b32 v7, 3, v8
    v_lshl_add_u32 v179, v7, 5, v9
    s_cmp_lg_u32 s30, 7
    s_cbranch_scc1 F_NOZF0
    v_mov_b32 v7, 154624
    v_mov_b32 v8, 0
    v_mov_b32 v9, 0
    v_lshl_add_u32 v7, v2, 3, v7
    v_mov_b32 v120, 0
    v_mov_b32 v121, 0
    ds_write_b64 v7, v[120:121]
    s_waitcnt vmcnt(0)
F_NOZF0:
    s_waitcnt vmcnt(8)
    ds_read_b64_tr_b16 v[208:209], v176 offset:0
    ds_read_b64_tr_b16 v[212:213], v177 offset:0
    ds_read_b64_tr_b16 v[216:217], v178 offset:0
    ds_read_b64_tr_b16 v[220:221], v179 offset:0
    ds_read_b64_tr_b16 v[210:211], v176 offset:2048
    ds_read_b64_tr_b16 v[214:215], v177 offset:2048
    ds_read_b64_tr_b16 v[218:219], v178 offset:2048
    ds_read_b64_tr_b16 v[222:223], v179 offset:2048
    ds_read_b64_tr_b16 v[224:225], v176 offset:40960
    ds_read_b64_tr_b16 v[228:229], v177 offset:40960
    ds_read_b64_tr_b16 v[232:233], v178 offset:40960
    ds_read_b64_tr_b16 v[236:237], v179 offset:40960
    ds_read_b64_tr_b16 v[226:227], v176 offset:43008
    ds_read_b64_tr_b16 v[230:231], v177 offset:43008
    ds_read_b64_tr_b16 v[234:235], v178 offset:43008
    ds_read_b64_tr_b16 v[238:239], v179 offset:43008
    s_waitcnt lgkmcnt(8)
    v_add_u32 v7, 81920, v176
    v_add_u32 v8, 81920, v177
    v_add_u32 v9, 81920, v178
    v_add_u32 v180, 81920, v179
    ds_read_b64_tr_b16 v[240:241], v7 offset:0
    ds_read_b64_tr_b16 v[242:243], v7 offset:2048
    ds_read_b64_tr_b16 v[244:245], v8 offset:0
    ds_read_b64_tr_b16 v[246:247], v8 offset:2048
    ds_read_b64_tr_b16 v[248:249], v9 offset:0
    ds_read_b64_tr_b16 v[250:251], v9 offset:2048
    ds_read_b64_tr_b16 v[252:253], v180 offset:0
    ds_read_b64_tr_b16 v[254:255], v180 offset:2048
    s_waitcnt lgkmcnt(0)
    s_barrier
    s_setprio 2
    v_lshl_or_b32 v14, v17, 16, v16
    v_lshl_or_b32 v15, v19, 16, v18
    v_cvt_pk_bf16_f32 v48, v88, v89
    v_cvt_pk_bf16_f32 v49, v90, v91
    v_cvt_pk_bf16_f32 v50, v92, v93
    v_cvt_pk_bf16_f32 v51, v94, v95
    v_cvt_pk_bf16_f32 v52, v96, v97
    v_cvt_pk_bf16_f32 v53, v98, v99
    v_cvt_pk_bf16_f32 v54, v100, v101
    v_cvt_pk_bf16_f32 v55, v102, v103
    v_mfma_f32_16x16x16_bf16 v[184:187], v[14:15], v[48:49], 0
    v_mfma_f32_16x16x16_bf16 v[188:191], v[14:15], v[50:51], 0
    v_mfma_f32_16x16x16_bf16 v[192:195], v[14:15], v[52:53], 0
    v_mfma_f32_16x16x16_bf16 v[196:199], v[14:15], v[54:55], 0
    v_cvt_pk_bf16_f32 v56, v104, v105
    v_cvt_pk_bf16_f32 v57, v106, v107
    v_cvt_pk_bf16_f32 v58, v108, v109
    v_cvt_pk_bf16_f32 v59, v110, v111
    v_cvt_pk_bf16_f32 v60, v112, v113
    v_cvt_pk_bf16_f32 v61, v114, v115
    v_cvt_pk_bf16_f32 v62, v116, v117
    v_cvt_pk_bf16_f32 v63, v118, v119
    v_cvt_pk_bf16_f32 v40, v72, v73
    v_cvt_pk_bf16_f32 v41, v74, v75
    v_cvt_pk_bf16_f32 v42, v76, v77
    v_cvt_pk_bf16_f32 v43, v78, v79
    v_cvt_pk_bf16_f32 v44, v80, v81
    v_cvt_pk_bf16_f32 v45, v82, v83
    v_cvt_pk_bf16_f32 v46, v84, v85
    v_cvt_pk_bf16_f32 v47, v86, v87
    v_mfma_f32_16x16x16_bf16 v[20:23], v[14:15], v[40:41], 0
    v_mfma_f32_16x16x16_bf16 v[24:27], v[14:15], v[42:43], 0
    v_mfma_f32_16x16x16_bf16 v[28:31], v[14:15], v[44:45], 0
    v_mfma_f32_16x16x16_bf16 v[32:35], v[14:15], v[46:47], 0
    v_lshlrev_b32 v7, 2, v4
    v_sub_u32 v7, v3, v7
    v_mov_b32 v168, 0
    v_mov_b32 v169, 0
    v_mov_b32 v172, 0
    v_mov_b32 v173, 0
    v_mov_b32 v8, 0x3f80
    v_cmp_eq_u32 vcc, 0, v7
    s_nop 1
    v_cndmask_b32 v170, 0, v8, vcc
    v_cmp_eq_u32 vcc, 2, v7
    s_nop 1
    v_cndmask_b32 v171, 0, v8, vcc
    v_mov_b32 v8, 0x3f800000
    v_cmp_eq_u32 vcc, 1, v7
    s_nop 1
    v_cndmask_b32 v170, v170, v8, vcc
    v_cmp_eq_u32 vcc, 3, v7
    s_nop 1
    v_cndmask_b32 v171, v171, v8, vcc
    v_max3_f32 v120, v184, v185, v186
    v_max3_f32 v132, v188, v189, v190
    v_max3_f32 v144, v192, v193, v194
    v_max3_f32 v156, v196, v197, v198
    v_max3_f32 v121, -v184, -v185, -v186
    v_max3_f32 v133, -v188, -v189, -v190
    v_max3_f32 v145, -v192, -v193, -v194
    v_max3_f32 v157, -v196, -v197, -v198
    v_max_f32 v120, v120, v187
    v_max_f32 v132, v132, v191
    v_max_f32 v144, v144, v195
    v_max_f32 v156, v156, v199
    v_max_f32_e64 v121, v121, -v187
    v_max_f32_e64 v133, v133, -v191
    v_max_f32_e64 v145, v145, -v195
    v_max_f32_e64 v157, v157, -v199
    v_permlane32_swap_b32 v120, v121
    v_permlane32_swap_b32 v132, v133
    v_permlane32_swap_b32 v144, v145
    v_permlane32_swap_b32 v156, v157
    v_max_f32 v122, v120, v121
    v_max_f32 v134, v132, v133
    v_max_f32 v146, v144, v145
    v_max_f32 v158, v156, v157
    v_mov_b32 v123, v122
    v_mov_b32 v135, v134
    v_mov_b32 v147, v146
    v_mov_b32 v159, v158
    v_permlane16_swap_b32 v122, v123
    v_permlane16_swap_b32 v134, v135
    v_permlane16_swap_b32 v146, v147
    v_permlane16_swap_b32 v158, v159
    v_max_f32 v120, v122, v123
    v_max_f32 v132, v134, v135
    v_max_f32 v144, v146, v147
    v_max_f32 v156, v158, v159
    v_mov_b32 v121, v120
    v_mov_b32 v133, v132
    v_mov_b32 v145, v144
    v_mov_b32 v157, v156
    v_permlane32_swap_b32 v120, v121
    v_permlane32_swap_b32 v132, v133
    v_permlane32_swap_b32 v144, v145
    v_permlane32_swap_b32 v156, v157
    v_pk_mul_f32 v[120:121], v[120:121], s[66:67]
    v_pk_mul_f32 v[132:133], v[132:133], s[66:67]
    v_pk_mul_f32 v[144:145], v[144:145], s[66:67]
    v_pk_mul_f32 v[156:157], v[156:157], s[66:67]
    v_pk_fma_f32 v[124:125], v[184:185], s[66:67], v[120:121] op_sel_hi:[1,1,0] neg_lo:[0,0,1] neg_hi:[0,0,1]
    v_pk_fma_f32 v[136:137], v[188:189], s[66:67], v[132:133] op_sel_hi:[1,1,0] neg_lo:[0,0,1] neg_hi:[0,0,1]
    v_pk_fma_f32 v[148:149], v[192:193], s[66:67], v[144:145] op_sel_hi:[1,1,0] neg_lo:[0,0,1] neg_hi:[0,0,1]
    v_pk_fma_f32 v[160:161], v[196:197], s[66:67], v[156:157] op_sel_hi:[1,1,0] neg_lo:[0,0,1] neg_hi:[0,0,1]
    v_pk_fma_f32 v[126:127], v[186:187], s[66:67], v[120:121] op_sel_hi:[1,1,0] neg_lo:[0,0,1] neg_hi:[0,0,1]
    v_pk_fma_f32 v[138:139], v[190:191], s[66:67], v[132:133] op_sel_hi:[1,1,0] neg_lo:[0,0,1] neg_hi:[0,0,1]
    v_pk_fma_f32 v[150:151], v[194:195], s[66:67], v[144:145] op_sel_hi:[1,1,0] neg_lo:[0,0,1] neg_hi:[0,0,1]
    v_pk_fma_f32 v[162:163], v[198:199], s[66:67], v[156:157] op_sel_hi:[1,1,0] neg_lo:[0,0,1] neg_hi:[0,0,1]
    v_pk_fma_f32 v[128:129], v[184:185], s[66:67], v[120:121] op_sel:[0,0,1] op_sel_hi:[1,1,1] neg_lo:[0,1,1] neg_hi:[0,1,1]
    v_pk_fma_f32 v[140:141], v[188:189], s[66:67], v[132:133] op_sel:[0,0,1] op_sel_hi:[1,1,1] neg_lo:[0,1,1] neg_hi:[0,1,1]
    v_pk_fma_f32 v[152:153], v[192:193], s[66:67], v[144:145] op_sel:[0,0,1] op_sel_hi:[1,1,1] neg_lo:[0,1,1] neg_hi:[0,1,1]
    v_pk_fma_f32 v[164:165], v[196:197], s[66:67], v[156:157] op_sel:[0,0,1] op_sel_hi:[1,1,1] neg_lo:[0,1,1] neg_hi:[0,1,1]
    v_pk_fma_f32 v[130:131], v[186:187], s[66:67], v[120:121] op_sel:[0,0,1] op_sel_hi:[1,1,1] neg_lo:[0,1,1] neg_hi:[0,1,1]
    v_pk_fma_f32 v[142:143], v[190:191], s[66:67], v[132:133] op_sel:[0,0,1] op_sel_hi:[1,1,1] neg_lo:[0,1,1] neg_hi:[0,1,1]
    v_pk_fma_f32 v[154:155], v[194:195], s[66:67], v[144:145] op_sel:[0,0,1] op_sel_hi:[1,1,1] neg_lo:[0,1,1] neg_hi:[0,1,1]
    v_pk_fma_f32 v[166:167], v[198:199], s[66:67], v[156:157] op_sel:[0,0,1] op_sel_hi:[1,1,1] neg_lo:[0,1,1] neg_hi:[0,1,1]
    v_exp_f32 v124, v124
    v_exp_f32 v136, v136
    v_exp_f32 v148, v148
    v_exp_f32 v160, v160
    v_exp_f32 v125, v125
    v_exp_f32 v137, v137
    v_exp_f32 v149, v149
    v_exp_f32 v161, v161
    v_exp_f32 v126, v126
    v_exp_f32 v138, v138
    v_exp_f32 v150, v150
    v_exp_f32 v162, v162
    v_exp_f32 v127, v127
    v_exp_f32 v139, v139
    v_exp_f32 v151, v151
    v_exp_f32 v163, v163
    v_exp_f32 v128, v128
    v_exp_f32 v140, v140
    v_exp_f32 v152, v152
    v_exp_f32 v164, v164
    v_exp_f32 v129, v129
    v_exp_f32 v141, v141
    v_exp_f32 v153, v153
    v_exp_f32 v165, v165
    v_exp_f32 v130, v130
    v_exp_f32 v142, v142
    v_exp_f32 v154, v154
    v_exp_f32 v166, v166
    v_exp_f32 v131, v131
    v_exp_f32 v143, v143
    v_exp_f32 v155, v155
    v_exp_f32 v167, v167
    v_pk_add_f32 v[122:123], v[124:125], v[126:127]
    v_pk_add_f32 v[134:135], v[136:137], v[138:139]
    v_pk_add_f32 v[146:147], v[148:149], v[150:151]
    v_pk_add_f32 v[158:159], v[160:161], v[162:163]
    v_add_f32 v120, v122, v123
    v_add_f32 v132, v134, v135
    v_add_f32 v144, v146, v147
    v_add_f32 v156, v158, v159
    v_pk_add_f32 v[122:123], v[128:129], v[130:131]
    v_pk_add_f32 v[134:135], v[140:141], v[142:143]
    v_pk_add_f32 v[146:147], v[152:153], v[154:155]
    v_pk_add_f32 v[158:159], v[164:165], v[166:167]
    v_add_f32 v121, v122, v123
    v_add_f32 v133, v134, v135
    v_add_f32 v145, v146, v147
    v_add_f32 v157, v158, v159
    v_permlane32_swap_b32 v120, v121
    v_permlane32_swap_b32 v132, v133
    v_permlane32_swap_b32 v144, v145
    v_permlane32_swap_b32 v156, v157
    v_add_f32 v122, v120, v121
    v_add_f32 v134, v132, v133
    v_add_f32 v146, v144, v145
    v_add_f32 v158, v156, v157
    v_mov_b32 v123, v122
    v_mov_b32 v135, v134
    v_mov_b32 v147, v146
    v_mov_b32 v159, v158
    v_permlane16_swap_b32 v122, v123
    v_permlane16_swap_b32 v134, v135
    v_permlane16_swap_b32 v146, v147
    v_permlane16_swap_b32 v158, v159
    v_add_f32 v120, v122, v123
    v_add_f32 v132, v134, v135
    v_add_f32 v144, v146, v147
    v_add_f32 v156, v158, v159
    v_mov_b32 v121, v120
    v_mov_b32 v133, v132
    v_mov_b32 v145, v144
    v_mov_b32 v157, v156
    v_permlane32_swap_b32 v120, v121
    v_permlane32_swap_b32 v132, v133
    v_permlane32_swap_b32 v144, v145
    v_permlane32_swap_b32 v156, v157
    v_rcp_f32 v120, v120
    v_rcp_f32 v132, v132
    v_rcp_f32 v144, v144
    v_rcp_f32 v156, v156
    v_rcp_f32 v121, v121
    v_rcp_f32 v133, v133
    v_rcp_f32 v145, v145
    v_rcp_f32 v157, v157
    v_pk_mul_f32 v[124:125], v[124:125], v[120:121] op_sel_hi:[1,0]
    v_pk_mul_f32 v[136:137], v[136:137], v[132:133] op_sel_hi:[1,0]
    v_pk_mul_f32 v[148:149], v[148:149], v[144:145] op_sel_hi:[1,0]
    v_pk_mul_f32 v[160:161], v[160:161], v[156:157] op_sel_hi:[1,0]
    v_pk_mul_f32 v[126:127], v[126:127], v[120:121] op_sel_hi:[1,0]
    v_pk_mul_f32 v[138:139], v[138:139], v[132:133] op_sel_hi:[1,0]
    v_pk_mul_f32 v[150:151], v[150:151], v[144:145] op_sel_hi:[1,0]
    v_pk_mul_f32 v[162:163], v[162:163], v[156:157] op_sel_hi:[1,0]
    v_pk_mul_f32 v[128:129], v[128:129], v[120:121] op_sel:[0,1] op_sel_hi:[1,1]
    v_pk_mul_f32 v[140:141], v[140:141], v[132:133] op_sel:[0,1] op_sel_hi:[1,1]
    v_pk_mul_f32 v[152:153], v[152:153], v[144:145] op_sel:[0,1] op_sel_hi:[1,1]
    v_pk_mul_f32 v[164:165], v[164:165], v[156:157] op_sel:[0,1] op_sel_hi:[1,1]
    v_pk_mul_f32 v[130:131], v[130:131], v[120:121] op_sel:[0,1] op_sel_hi:[1,1]
    v_pk_mul_f32 v[142:143], v[142:143], v[132:133] op_sel:[0,1] op_sel_hi:[1,1]
    v_pk_mul_f32 v[154:155], v[154:155], v[144:145] op_sel:[0,1] op_sel_hi:[1,1]
    v_pk_mul_f32 v[166:167], v[166:167], v[156:157] op_sel:[0,1] op_sel_hi:[1,1]
    v_cvt_pk_bf16_f32 v88, v124, v125
    v_cvt_pk_bf16_f32 v92, v136, v137
    v_cvt_pk_bf16_f32 v96, v148, v149
    v_cvt_pk_bf16_f32 v100, v160, v161
    v_cvt_pk_bf16_f32 v89, v126, v127
    v_cvt_pk_bf16_f32 v93, v138, v139
    v_cvt_pk_bf16_f32 v97, v150, v151
    v_cvt_pk_bf16_f32 v101, v162, v163
    v_cvt_pk_bf16_f32 v90, v128, v129
    v_cvt_pk_bf16_f32 v94, v140, v141
    v_cvt_pk_bf16_f32 v98, v152, v153
    v_cvt_pk_bf16_f32 v102, v164, v165
    v_cvt_pk_bf16_f32 v91, v130, v131
    v_cvt_pk_bf16_f32 v95, v142, v143
    v_cvt_pk_bf16_f32 v99, v154, v155
    v_cvt_pk_bf16_f32 v103, v166, v167
    v_mfma_f32_16x16x32_bf16 v[184:187], v[88:91], v[170:173], 0
    v_mfma_f32_16x16x32_bf16 v[120:123], v[88:91], v[168:171], 0
    v_mfma_f32_16x16x32_bf16 v[188:191], v[92:95], v[170:173], 0
    v_mfma_f32_16x16x32_bf16 v[124:127], v[92:95], v[168:171], 0
    v_mfma_f32_16x16x32_bf16 v[192:195], v[96:99], v[170:173], 0
    v_mfma_f32_16x16x32_bf16 v[128:131], v[96:99], v[168:171], 0
    v_mfma_f32_16x16x32_bf16 v[196:199], v[100:103], v[170:173], 0
    v_mfma_f32_16x16x32_bf16 v[132:135], v[100:103], v[168:171], 0
    s_lshl_b32 s3, s28, 1
    s_add_u32 s3, s3, s31
    s_lshl_b32 s100, s3, 2
    s_mul_i32 s3, s29, 8704
    s_add_u32 s3, s3, 10485760
    s_lshl_b32 s4, s32, 11
    s_add_u32 s4, s4, s3
    v_lshlrev_b32 v7, 2, v2
    v_add_u32 v7, s4, v7
    s_lshl_b32 s4, s32, 7
    s_add_u32 s4, s4, s3
    s_add_u32 s4, s4, 8192
    v_lshlrev_b32 v8, 5, v4
    v_lshl_add_u32 v8, v3, 2, v8
    v_add_u32 v8, s4, v8
    v_cvt_pk_bf16_f32 v88, v184, v185
    v_cvt_pk_bf16_f32 v89, v186, v187
    v_cvt_pk_bf16_f32 v96, v120, v121
    v_cvt_pk_bf16_f32 v97, v122, v123
    v_cvt_pk_bf16_f32 v90, v188, v189
    v_cvt_pk_bf16_f32 v91, v190, v191
    v_cvt_pk_bf16_f32 v98, v124, v125
    v_cvt_pk_bf16_f32 v99, v126, v127
    v_cvt_pk_bf16_f32 v92, v192, v193
    v_cvt_pk_bf16_f32 v93, v194, v195
    v_cvt_pk_bf16_f32 v100, v128, v129
    v_cvt_pk_bf16_f32 v101, v130, v131
    v_cvt_pk_bf16_f32 v94, v196, v197
    v_cvt_pk_bf16_f32 v95, v198, v199
    v_cvt_pk_bf16_f32 v102, v132, v133
    v_cvt_pk_bf16_f32 v103, v134, v135
    v_mov_b32 v184, 0x3f803f80
    v_mov_b32 v185, 0x3f803f80
    v_mov_b32 v186, 0x3f803f80
    v_mov_b32 v187, 0x3f803f80
    v_mfma_f32_16x16x32_bf16 v[188:191], v[88:91], v[56:59], 0
    v_mfma_f32_16x16x32_bf16 v[192:195], v[96:99], v[56:59], 0
    v_mfma_f32_16x16x32_bf16 v[120:123], v[88:91], v[184:187], 0
    v_mfma_f32_16x16x32_bf16 v[124:127], v[96:99], v[184:187], 0
    v_mfma_f32_16x16x32_bf16 v[188:191], v[92:95], v[60:63], v[188:191]
    v_mfma_f32_16x16x32_bf16 v[192:195], v[100:103], v[60:63], v[192:195]
    v_mfma_f32_16x16x32_bf16 v[120:123], v[92:95], v[184:187], v[120:123]
    v_mfma_f32_16x16x32_bf16 v[124:127], v[100:103], v[184:187], v[124:127]
    s_add_u32 s3, s32, 0
    s_and_b32 s3, s3, 3
    s_lshl_b32 s4, s28, 3
    s_add_u32 s3, s3, s4
    s_lshl_b32 s4, s31, 2
    s_add_u32 s3, s3, s4
    s_lshl_b32 s3, s3, 5
    s_add_u32 s3, s3, s68
    s_lshl_b32 s3, s3, 10
    s_add_u32 s3, s3, 6291456
    v_lshlrev_b32 v9, 4, v2
    v_add_u32 v36, s3, v9
    s_add_u32 s3, s32, 1
    s_and_b32 s3, s3, 3
    s_lshl_b32 s4, s28, 3
    s_add_u32 s3, s3, s4
    s_lshl_b32 s4, s31, 2
    s_add_u32 s3, s3, s4
    s_lshl_b32 s3, s3, 5
    s_add_u32 s3, s3, s68
    s_lshl_b32 s3, s3, 10
    s_add_u32 s3, s3, 6291456
    v_lshlrev_b32 v9, 4, v2
    v_add_u32 v37, s3, v9
    s_add_u32 s3, s32, 2
    s_and_b32 s3, s3, 3
    s_lshl_b32 s4, s28, 3
    s_add_u32 s3, s3, s4
    s_lshl_b32 s4, s31, 2
    s_add_u32 s3, s3, s4
    s_lshl_b32 s3, s3, 5
    s_add_u32 s3, s3, s68
    s_lshl_b32 s3, s3, 10
    s_add_u32 s3, s3, 6291456
    v_lshlrev_b32 v9, 4, v2
    v_add_u32 v38, s3, v9
    s_add_u32 s3, s32, 3
    s_and_b32 s3, s3, 3
    s_lshl_b32 s4, s28, 3
    s_add_u32 s3, s3, s4
    s_lshl_b32 s4, s31, 2
    s_add_u32 s3, s3, s4
    s_lshl_b32 s3, s3, 5
    s_add_u32 s3, s3, s68
    s_lshl_b32 s3, s3, 10
    s_add_u32 s3, s3, 6291456
    v_lshlrev_b32 v9, 4, v2
    v_add_u32 v39, s3, v9
    buffer_atomic_add_f32 v188, v7, s[16:19], 0 offen offset:0 sc1
    buffer_atomic_add_f32 v189, v7, s[16:19], 0 offen offset:256 sc1
    buffer_atomic_add_f32 v190, v7, s[16:19], 0 offen offset:512 sc1
    buffer_atomic_add_f32 v191, v7, s[16:19], 0 offen offset:768 sc1
    buffer_atomic_add_f32 v192, v7, s[16:19], 0 offen offset:1024 sc1
    buffer_atomic_add_f32 v193, v7, s[16:19], 0 offen offset:1280 sc1
    buffer_atomic_add_f32 v194, v7, s[16:19], 0 offen offset:1536 sc1
    buffer_atomic_add_f32 v195, v7, s[16:19], 0 offen offset:1792 sc1
    v_and_b32 v9, 1, v3
    v_cmp_eq_u32 vcc, 1, v9
    s_nop 1
    v_cndmask_b32 v120, v120, v121, vcc
    v_cndmask_b32 v122, v122, v123, vcc
    v_cndmask_b32 v124, v124, v125, vcc
    v_cndmask_b32 v126, v126, v127, vcc
    v_and_b32 v9, 2, v3
    v_cmp_eq_u32 vcc, 2, v9
    s_nop 1
    v_cndmask_b32 v120, v120, v122, vcc
    v_cndmask_b32 v124, v124, v126, vcc
    v_and_b32 v9, 4, v3
    v_cmp_eq_u32 vcc, 4, v9
    s_nop 1
    v_cndmask_b32 v120, v120, v124, vcc
    v_cmp_gt_u32 vcc, 8, v3
    s_nop 2
    s_and_saveexec_b64 s[6:7], vcc
    buffer_atomic_add_f32 v120, v8, s[16:19], 0 offen sc1
    s_mov_b64 exec, s[6:7]
    s_waitcnt vmcnt(0)
    s_movk_i32 s5, 23552
    s_add_u32 s5, s5, 131088
    v_mov_b32 v7, s5
    v_mov_b32 v8, 1
    s_mov_b64 s[6:7], exec
    s_mov_b64 exec, 1
    ds_add_rtn_u32 v8, v7, v8
    s_waitcnt lgkmcnt(0)
    v_readfirstlane_b32 s4, v8
    s_nop 2
    s_mov_b32 s41, s4
    s_cmp_lg_u32 s4, 7
    s_cbranch_scc1 F_KVS
    v_mov_b32 v7, 13112320
    v_mov_b32 v174, 1
    buffer_atomic_add v174, v7, s[16:19], 0 offen sc0 sc1
F_KVS:
    s_mov_b64 exec, s[6:7]
    s_setprio 0
    v_max3_f32 v136, v20, v21, v22
    v_max3_f32 v148, v24, v25, v26
    v_max3_f32 v104, v28, v29, v30
    v_max3_f32 v160, v32, v33, v34
    v_max3_f32 v137, -v20, -v21, -v22
    v_max3_f32 v149, -v24, -v25, -v26
    v_max3_f32 v105, -v28, -v29, -v30
    v_max3_f32 v161, -v32, -v33, -v34
    v_max_f32 v136, v136, v23
    v_max_f32 v148, v148, v27
    v_max_f32 v104, v104, v31
    v_max_f32 v160, v160, v35
    v_max_f32_e64 v137, v137, -v23
    v_max_f32_e64 v149, v149, -v27
    s_add_u32 m0, s34, 0
    s_add_u32 s39, s36, 344064
    buffer_load_dwordx4 v12, s[8:11], s39 offen lds
    v_max_f32_e64 v105, v105, -v31
    v_max_f32_e64 v161, v161, -v35
    v_permlane32_swap_b32 v136, v137
    v_permlane32_swap_b32 v148, v149
    v_permlane32_swap_b32 v104, v105
    v_permlane32_swap_b32 v160, v161
    v_max_f32 v138, v136, v137
    v_max_f32 v150, v148, v149
    v_max_f32 v106, v104, v105
    v_max_f32 v162, v160, v161
    v_mov_b32 v139, v138
    v_mov_b32 v151, v150
    v_mov_b32 v107, v106
    v_mov_b32 v163, v162
    s_add_u32 m0, s34, 1024
    s_add_u32 s39, s36, 352256
    buffer_load_dwordx4 v12, s[8:11], s39 offen lds
    v_permlane16_swap_b32 v138, v139
    v_permlane16_swap_b32 v150, v151
    v_permlane16_swap_b32 v106, v107
    v_permlane16_swap_b32 v162, v163
    v_max_f32 v136, v138, v139
    v_max_f32 v148, v150, v151
    v_max_f32 v104, v106, v107
    v_max_f32 v160, v162, v163
    v_mov_b32 v137, v136
    v_mov_b32 v149, v148
    v_mov_b32 v105, v104
    v_mov_b32 v161, v160
    v_permlane32_swap_b32 v136, v137
    v_permlane32_swap_b32 v148, v149
    s_add_u32 m0, s34, 2048
    s_add_u32 s39, s36, 360448
    buffer_load_dwordx4 v12, s[8:11], s39 offen lds
    v_permlane32_swap_b32 v104, v105
    v_permlane32_swap_b32 v160, v161
    v_pk_mul_f32 v[136:137], v[136:137], s[66:67]
    v_pk_mul_f32 v[148:149], v[148:149], s[66:67]
    v_pk_mul_f32 v[104:105], v[104:105], s[66:67]
    v_pk_mul_f32 v[160:161], v[160:161], s[66:67]
    v_pk_fma_f32 v[140:141], v[20:21], s[66:67], v[136:137] op_sel_hi:[1,1,0] neg_lo:[0,0,1] neg_hi:[0,0,1]
    v_pk_fma_f32 v[152:153], v[24:25], s[66:67], v[148:149] op_sel_hi:[1,1,0] neg_lo:[0,0,1] neg_hi:[0,0,1]
    v_pk_fma_f32 v[108:109], v[28:29], s[66:67], v[104:105] op_sel_hi:[1,1,0] neg_lo:[0,0,1] neg_hi:[0,0,1]
    v_pk_fma_f32 v[164:165], v[32:33], s[66:67], v[160:161] op_sel_hi:[1,1,0] neg_lo:[0,0,1] neg_hi:[0,0,1]
    v_pk_fma_f32 v[142:143], v[22:23], s[66:67], v[136:137] op_sel_hi:[1,1,0] neg_lo:[0,0,1] neg_hi:[0,0,1]
    v_pk_fma_f32 v[154:155], v[26:27], s[66:67], v[148:149] op_sel_hi:[1,1,0] neg_lo:[0,0,1] neg_hi:[0,0,1]
    v_pk_fma_f32 v[110:111], v[30:31], s[66:67], v[104:105] op_sel_hi:[1,1,0] neg_lo:[0,0,1] neg_hi:[0,0,1]
    v_pk_fma_f32 v[166:167], v[34:35], s[66:67], v[160:161] op_sel_hi:[1,1,0] neg_lo:[0,0,1] neg_hi:[0,0,1]
    s_add_u32 m0, s34, 3072
    s_add_u32 s39, s36, 368640
    buffer_load_dwordx4 v12, s[8:11], s39 offen lds
    v_pk_fma_f32 v[144:145], v[20:21], s[66:67], v[136:137] op_sel:[0,0,1] op_sel_hi:[1,1,1] neg_lo:[0,1,1] neg_hi:[0,1,1]
    v_pk_fma_f32 v[156:157], v[24:25], s[66:67], v[148:149] op_sel:[0,0,1] op_sel_hi:[1,1,1] neg_lo:[0,1,1] neg_hi:[0,1,1]
    v_pk_fma_f32 v[112:113], v[28:29], s[66:67], v[104:105] op_sel:[0,0,1] op_sel_hi:[1,1,1] neg_lo:[0,1,1] neg_hi:[0,1,1]
    v_pk_fma_f32 v[168:169], v[32:33], s[66:67], v[160:161] op_sel:[0,0,1] op_sel_hi:[1,1,1] neg_lo:[0,1,1] neg_hi:[0,1,1]
    v_pk_fma_f32 v[146:147], v[22:23], s[66:67], v[136:137] op_sel:[0,0,1] op_sel_hi:[1,1,1] neg_lo:[0,1,1] neg_hi:[0,1,1]
    v_pk_fma_f32 v[158:159], v[26:27], s[66:67], v[148:149] op_sel:[0,0,1] op_sel_hi:[1,1,1] neg_lo:[0,1,1] neg_hi:[0,1,1]
    v_pk_fma_f32 v[114:115], v[30:31], s[66:67], v[104:105] op_sel:[0,0,1] op_sel_hi:[1,1,1] neg_lo:[0,1,1] neg_hi:[0,1,1]
    v_pk_fma_f32 v[170:171], v[34:35], s[66:67], v[160:161] op_sel:[0,0,1] op_sel_hi:[1,1,1] neg_lo:[0,1,1] neg_hi:[0,1,1]
    v_exp_f32 v140, v140
    v_exp_f32 v152, v152
    v_exp_f32 v108, v108
    v_exp_f32 v164, v164
    v_exp_f32 v141, v141
    v_exp_f32 v153, v153
    s_add_u32 m0, s34, 40960
    s_add_u32 s39, s36, 376832
    buffer_load_dwordx4 v12, s[8:11], s39 offen lds
    v_exp_f32 v109, v109
    v_exp_f32 v165, v165
    v_exp_f32 v142, v142
    v_exp_f32 v154, v154
    v_exp_f32 v110, v110
    v_exp_f32 v166, v166
    v_exp_f32 v143, v143
    v_exp_f32 v155, v155
    v_exp_f32 v111, v111
    v_exp_f32 v167, v167
    v_exp_f32 v144, v144
    v_exp_f32 v156, v156
    v_exp_f32 v112, v112
    v_exp_f32 v168, v168
    s_add_u32 m0, s34, 41984
    s_add_u32 s39, s36, 385024
    buffer_load_dwordx4 v12, s[8:11], s39 offen lds
    v_exp_f32 v145, v145
    v_exp_f32 v157, v157
    v_exp_f32 v113, v113
    v_exp_f32 v169, v169
    v_exp_f32 v146, v146
    v_exp_f32 v158, v158
    v_exp_f32 v114, v114
    v_exp_f32 v170, v170
    v_exp_f32 v147, v147
    v_exp_f32 v159, v159
    v_exp_f32 v115, v115
    v_exp_f32 v171, v171
    v_pk_add_f32 v[138:139], v[140:141], v[142:143]
    s_add_u32 m0, s34, 43008
    s_add_u32 s39, s36, 720896
    buffer_load_dwordx4 v12, s[8:11], s39 offen lds
    v_pk_add_f32 v[150:151], v[152:153], v[154:155]
    v_pk_add_f32 v[106:107], v[108:109], v[110:111]
    v_pk_add_f32 v[162:163], v[164:165], v[166:167]
    v_add_f32 v136, v138, v139
    v_add_f32 v148, v150, v151
    v_add_f32 v104, v106, v107
    v_add_f32 v160, v162, v163
    v_pk_add_f32 v[138:139], v[144:145], v[146:147]
    v_pk_add_f32 v[150:151], v[156:157], v[158:159]
    v_pk_add_f32 v[106:107], v[112:113], v[114:115]
    v_pk_add_f32 v[162:163], v[168:169], v[170:171]
    v_add_f32 v137, v138, v139
    v_add_f32 v149, v150, v151
    v_add_f32 v105, v106, v107
    s_add_u32 m0, s34, 44032
    s_add_u32 s39, s36, 729088
    buffer_load_dwordx4 v12, s[8:11], s39 offen lds
    v_add_f32 v161, v162, v163
    v_permlane32_swap_b32 v136, v137
    v_permlane32_swap_b32 v148, v149
    v_permlane32_swap_b32 v104, v105
    v_permlane32_swap_b32 v160, v161
    v_add_f32 v138, v136, v137
    v_add_f32 v150, v148, v149
    v_add_f32 v106, v104, v105
    v_add_f32 v162, v160, v161
    v_mov_b32 v139, v138
    v_mov_b32 v151, v150
    v_mov_b32 v107, v106
    v_mov_b32 v163, v162
    v_permlane16_swap_b32 v138, v139
    s_add_u32 m0, s34, 81920
    s_add_u32 s39, s36, 688128
    buffer_load_dwordx4 v12, s[8:11], s39 offen lds
    v_permlane16_swap_b32 v150, v151
    v_permlane16_swap_b32 v106, v107
    v_permlane16_swap_b32 v162, v163
    v_add_f32 v136, v138, v139
    v_add_f32 v148, v150, v151
    v_add_f32 v104, v106, v107
    v_add_f32 v160, v162, v163
    v_mov_b32 v137, v136
    v_mov_b32 v149, v148
    v_mov_b32 v105, v104
    v_mov_b32 v161, v160
    v_permlane32_swap_b32 v136, v137
    v_permlane32_swap_b32 v148, v149
    v_permlane32_swap_b32 v104, v105
    s_add_u32 m0, s34, 82944
    s_add_u32 s39, s36, 696320
    buffer_load_dwordx4 v12, s[8:11], s39 offen lds
    v_permlane32_swap_b32 v160, v161
    v_rcp_f32 v136, v136
    v_rcp_f32 v148, v148
    v_rcp_f32 v104, v104
    v_rcp_f32 v160, v160
    v_rcp_f32 v137, v137
    v_rcp_f32 v149, v149
    v_rcp_f32 v105, v105
    v_rcp_f32 v161, v161
    v_pk_mul_f32 v[140:141], v[140:141], v[136:137] op_sel_hi:[1,0]
    v_pk_mul_f32 v[152:153], v[152:153], v[148:149] op_sel_hi:[1,0]
    v_pk_mul_f32 v[108:109], v[108:109], v[104:105] op_sel_hi:[1,0]
    v_pk_mul_f32 v[164:165], v[164:165], v[160:161] op_sel_hi:[1,0]
    v_pk_mul_f32 v[142:143], v[142:143], v[136:137] op_sel_hi:[1,0]
    s_add_u32 m0, s34, 83968
    s_add_u32 s39, s36, 704512
    buffer_load_dwordx4 v12, s[8:11], s39 offen lds
    v_pk_mul_f32 v[154:155], v[154:155], v[148:149] op_sel_hi:[1,0]
    v_pk_mul_f32 v[110:111], v[110:111], v[104:105] op_sel_hi:[1,0]
    v_pk_mul_f32 v[166:167], v[166:167], v[160:161] op_sel_hi:[1,0]
    v_pk_mul_f32 v[144:145], v[144:145], v[136:137] op_sel:[0,1] op_sel_hi:[1,1]
    v_pk_mul_f32 v[156:157], v[156:157], v[148:149] op_sel:[0,1] op_sel_hi:[1,1]
    v_pk_mul_f32 v[112:113], v[112:113], v[104:105] op_sel:[0,1] op_sel_hi:[1,1]
    v_pk_mul_f32 v[168:169], v[168:169], v[160:161] op_sel:[0,1] op_sel_hi:[1,1]
    v_pk_mul_f32 v[146:147], v[146:147], v[136:137] op_sel:[0,1] op_sel_hi:[1,1]
    v_pk_mul_f32 v[158:159], v[158:159], v[148:149] op_sel:[0,1] op_sel_hi:[1,1]
    v_pk_mul_f32 v[114:115], v[114:115], v[104:105] op_sel:[0,1] op_sel_hi:[1,1]
    v_pk_mul_f32 v[170:171], v[170:171], v[160:161] op_sel:[0,1] op_sel_hi:[1,1]
    v_cvt_pk_bf16_f32 v72, v140, v141
    v_cvt_pk_bf16_f32 v76, v152, v153
    v_cvt_pk_bf16_f32 v80, v108, v109
    s_add_u32 m0, s34, 84992
    s_add_u32 s39, s36, 712704
    buffer_load_dwordx4 v12, s[8:11], s39 offen lds
    v_cvt_pk_bf16_f32 v84, v164, v165
    v_cvt_pk_bf16_f32 v73, v142, v143
    v_cvt_pk_bf16_f32 v77, v154, v155
    v_cvt_pk_bf16_f32 v81, v110, v111
    v_cvt_pk_bf16_f32 v85, v166, v167
    v_cvt_pk_bf16_f32 v74, v144, v145
    v_cvt_pk_bf16_f32 v78, v156, v157
    v_cvt_pk_bf16_f32 v82, v112, v113
    v_cvt_pk_bf16_f32 v86, v168, v169
    v_cvt_pk_bf16_f32 v75, v146, v147
    v_cvt_pk_bf16_f32 v79, v158, v159
    v_cvt_pk_bf16_f32 v83, v114, v115
    v_cvt_pk_bf16_f32 v87, v170, v171
    s_cmp_lg_u32 s41, 7
    s_cbranch_scc1 F_KVS2
    s_waitcnt vmcnt(12)
    v_readfirstlane_b32 s4, v174
    s_nop 2
    s_cmp_lg_u32 s4, 127
    s_cbranch_scc1 F_KVS2
    s_mov_b64 s[6:7], exec
    s_mov_b32 exec_lo, -1
    s_mov_b32 exec_hi, 0
    v_lshlrev_b32 v7, 8, v2
    v_add_u32 v7, 13115392, v7
    v_mov_b32 v8, 1
    buffer_store_dword v8, v7, s[16:19], 0 offen sc1
    s_mov_b64 exec, s[6:7]
F_KVS2:
    buffer_store_dwordx4 v[72:75], v36, s[16:19], 0 offen sc1
    buffer_store_dwordx4 v[76:79], v37, s[16:19], 0 offen sc1
    buffer_store_dwordx4 v[80:83], v38, s[16:19], 0 offen sc1
    buffer_store_dwordx4 v[84:87], v39, s[16:19], 0 offen sc1
    s_waitcnt vmcnt(0)
    s_lshl_b32 s5, s31, 2
    s_add_u32 s5, s5, 154644
    v_mov_b32 v7, s5
    v_mov_b32 v8, 1
    s_mov_b64 s[6:7], exec
    s_mov_b64 exec, 1
    ds_add_rtn_u32 v8, v7, v8
    s_waitcnt lgkmcnt(0)
    v_readfirstlane_b32 s4, v8
    s_nop 2
    s_cmp_lg_u32 s4, 3
    s_cbranch_scc1 F_SIG0
    s_lshl_b32 s3, s100, 5
    s_lshl_b32 s4, s29, 2
    s_add_u32 s3, s3, s4
    s_add_u32 s3, s3, 13107232
    v_mov_b32 v7, s3
    v_mov_b32 v8, 1
    buffer_store_dword v8, v7, s[16:19], 0 offen sc1
F_SIG0:
    s_mov_b64 exec, s[6:7]
    s_branch F_PHASE2
F_HTYPE:
    s_mul_i32 s34, s29, 384
    s_add_u32 s35, s34, 128
    s_add_u32 s36, s34, 256
    v_and_b32 v3, 15, v2
    v_lshrrev_b32 v4, 4, v2
    v_and_b32 v5, 7, v2
    v_lshrrev_b32 v6, 3, v2
    s_lshl_b32 s3, s30, 4
    v_add_u32 v7, s3, v6
    v_lshlrev_b32 v7, 10, v7
    v_xor_b32 v8, v5, v6
    v_lshl_add_u32 v10, v8, 4, v7
    s_lshl_b32 s3, s30, 3
    v_add_u32 v7, s3, v6
    s_movk_i32 s3, 2752
    v_mul_lo_u32 v7, v7, s3
    v_and_b32 v8, 1, v4
    v_lshlrev_b32 v8, 1, v8
    s_and_b32 s3, s30, 1
    s_lshl_b32 s3, s3, 2
    v_or_b32 v8, s3, v8
    v_xor_b32 v8, v5, v8
    v_lshl_add_u32 v11, v8, 4, v7
    s_waitcnt lgkmcnt(0)
    s_mov_b32 s0, 1
    s_and_b32 s1, s28, 7
    s_lshl_b32 s3, s28, 17
    s_add_u32 s8, s40, s3
    s_addc_u32 s9, s41, 0
    s_mov_b32 s10, 0x20000
    s_mov_b32 s11, 0x00020000
    s_mov_b32 s12, s50
    s_mov_b32 s13, s51
    s_mov_b32 s14, 1409024
    s_mov_b32 s15, 0x00020000
    s_add_u32 s48, s1, 0
    s_and_b32 s48, s48, 7
    s_lshl_b32 s49, s48, 7
    s_mul_i32 s48, s48, 176128
    s_add_u32 m0, s37, 0
    s_nop 0
    buffer_load_dwordx4 v10, s[8:11], s49 offen lds
    s_add_u32 m0, s37, 1024
    s_add_u32 s49, s49, 8192
    buffer_load_dwordx4 v10, s[8:11], s49 offen lds
    s_add_u32 m0, s38, 0
    s_add_u32 s39, s34, s48
    buffer_load_dwordx4 v11, s[12:15], s39 offen lds
    s_add_u32 m0, s38, 8192
    s_add_u32 s39, s35, s48
    buffer_load_dwordx4 v11, s[12:15], s39 offen lds
    s_add_u32 m0, s38, 16384
    s_add_u32 s39, s36, s48
    buffer_load_dwordx4 v11, s[12:15], s39 offen lds
    s_mov_b32 s16, s64
    s_mov_b32 s17, s65
    s_mov_b32 s96, s62
    s_mov_b32 s97, s63
    s_cmp_lg_u32 s2, 0
    s_cbranch_scc1 F_NOCLR1
    v_mov_b32 v20, 0
    v_mov_b32 v21, 0
    v_mov_b32 v22, 0
    v_mov_b32 v23, 0
    v_lshlrev_b32 v24, 4, v0
    v_add_u32 v24, 13107200, v24
    v_add_u32 v25, 8192, v24
    buffer_store_dwordx4 v[20:23], v24, s[16:19], 0 offen sc1
    buffer_store_dwordx4 v[20:23], v25, s[16:19], 0 offen sc1
    s_mov_b64 s[6:7], exec
    s_lshl_b32 s3, s30, 2
    v_mov_b32 v24, s3
    v_mov_b32 v25, 1
    s_waitcnt vmcnt(0)
    s_mov_b64 exec, 1
    buffer_store_dword v25, v24, s[96:99], 0 offen offset:32 sc1
    s_mov_b64 exec, s[6:7]
F_NOCLR1:
    s_mov_b32 s96, s62
    s_mov_b32 s97, s63
    s_mov_b32 s98, 256
    s_mov_b32 s99, 0x00020000
    s_mov_b32 s24, s58
    s_mov_b32 s25, s59
    s_mov_b32 s26, 1024
    s_mov_b32 s27, 0x00020000
    s_mov_b32 s20, s52
    s_mov_b32 s21, s53
    s_mov_b32 s22, 2752
    s_mov_b32 s23, 0x00020000
    v_and_b32 v7, 6, v6
    v_xor_b32 v7, v5, v7
    v_lshlrev_b32 v7, 4, v7
    v_lshl_add_u32 v12, v6, 10, v7
    s_lshl_b32 s3, s69, 7
    v_add_u32 v12, s3, v12
    s_lshl_b32 s3, s29, 2
    s_add_u32 s68, s3, s32
    s_mul_i32 s3, s29, 384
    s_mul_i32 s4, s32, 96
    s_add_u32 s3, s3, s4
    v_lshlrev_b32 v7, 3, v4
    v_add_u32 v7, s3, v7
    buffer_load_dwordx2 v[14:15], v7, s[20:23], 0 offen offset:0
    buffer_load_dwordx2 v[16:17], v7, s[20:23], 0 offen offset:32
    buffer_load_dwordx2 v[18:19], v7, s[20:23], 0 offen offset:64
    s_lshl_b32 s3, s29, 3
    s_add_u32 s3, s3, s30
    s_add_u32 s3, s3, 64
    s_lshl_b32 s4, s3, 10
    v_lshlrev_b32 v7, 4, v2
    buffer_load_dwordx4 v[20:23], v7, s[8:11], s4 offen
    buffer_load_dwordx4 v[24:27], v7, s[24:27], 0 offen
    s_lshl_b32 s4, s28, 7
    s_add_u32 s3, s3, s4
    s_lshl_b32 s3, s3, 4
    s_add_u32 s101, s3, 13041664
    s_xor_b32 s3, s31, 0
    s_lshl_b32 s3, s3, 2
    v_add_u32 v7, s3, v4
    v_xor_b32 v7, v7, v5
    v_lshlrev_b32 v7, 4, v7
    v_lshl_add_u32 v7, v3, 7, v7
    s_add_u32 s3, s32, 0
    s_and_b32 s3, s3, 3
    s_lshl_b32 s3, s3, 11
    s_lshl_b32 s4, s31, 13
    s_add_u32 s3, s3, s4
    v_add_u32 v40, s3, v7
    v_add_u32 v48, 81920, v40
    s_add_u32 s3, s32, 1
    s_and_b32 s3, s3, 3
    s_lshl_b32 s3, s3, 11
    s_lshl_b32 s4, s31, 13
    s_add_u32 s3, s3, s4
    v_add_u32 v41, s3, v7
    v_add_u32 v49, 81920, v41
    s_add_u32 s3, s32, 2
    s_and_b32 s3, s3, 3
    s_lshl_b32 s3, s3, 11
    s_lshl_b32 s4, s31, 13
    s_add_u32 s3, s3, s4
    v_add_u32 v42, s3, v7
    v_add_u32 v50, 81920, v42
    s_add_u32 s3, s32, 3
    s_and_b32 s3, s3, 3
    s_lshl_b32 s3, s3, 11
    s_lshl_b32 s4, s31, 13
    s_add_u32 s3, s3, s4
    v_add_u32 v43, s3, v7
    v_add_u32 v51, 81920, v43
    s_xor_b32 s3, s31, 1
    s_lshl_b32 s3, s3, 2
    v_add_u32 v7, s3, v4
    v_xor_b32 v7, v7, v5
    v_lshlrev_b32 v7, 4, v7
    v_lshl_add_u32 v7, v3, 7, v7
    s_add_u32 s3, s32, 0
    s_and_b32 s3, s3, 3
    s_lshl_b32 s3, s3, 11
    s_lshl_b32 s4, s31, 13
    s_add_u32 s3, s3, s4
    v_add_u32 v44, s3, v7
    v_add_u32 v52, 81920, v44
    s_add_u32 s3, s32, 1
    s_and_b32 s3, s3, 3
    s_lshl_b32 s3, s3, 11
    s_lshl_b32 s4, s31, 13
    s_add_u32 s3, s3, s4
    v_add_u32 v45, s3, v7
    v_add_u32 v53, 81920, v45
    s_add_u32 s3, s32, 2
    s_and_b32 s3, s3, 3
    s_lshl_b32 s3, s3, 11
    s_lshl_b32 s4, s31, 13
    s_add_u32 s3, s3, s4
    v_add_u32 v46, s3, v7
    v_add_u32 v54, 81920, v46
    s_add_u32 s3, s32, 3
    s_and_b32 s3, s3, 3
    s_lshl_b32 s3, s3, 11
    s_lshl_b32 s4, s31, 13
    s_add_u32 s3, s3, s4
    v_add_u32 v47, s3, v7
    v_add_u32 v55, 81920, v47
    v_lshrrev_b32 v68, 2, v3
    v_lshrrev_b32 v69, 1, v68
    v_and_b32 v7, 1, v4
    v_lshl_or_b32 v69, v7, 1, v69
    v_lshl_add_u32 v70, v4, 3, v68
    v_lshlrev_b32 v70, 7, v70
    v_and_b32 v7, 3, v3
    v_lshl_add_u32 v70, v7, 3, v70
    s_mul_i32 s3, s32, 3
    s_add_u32 s3, s3, 0
    s_and_b32 s4, s3, 3
    s_lshr_b32 s5, s3, 2
    s_lshl_b32 s5, s5, 13
    v_xor_b32 v7, s4, v69
    v_lshl_add_u32 v7, v7, 5, v70
    s_xor_b32 s3, s31, 0
    s_lshl_b32 s3, s3, 12
    s_add_u32 s3, s3, s5
    s_add_u32 s3, s3, 16384
    v_add_u32 v56, s3, v7
    s_xor_b32 s3, s31, 0
    s_lshl_b32 s3, s3, 12
    s_add_u32 s3, s3, s5
    s_add_u32 s3, s3, 98304
    v_add_u32 v57, s3, v7
    s_xor_b32 s3, s31, 1
    s_lshl_b32 s3, s3, 12
    s_add_u32 s3, s3, s5
    s_add_u32 s3, s3, 16384
    v_add_u32 v58, s3, v7
    s_xor_b32 s3, s31, 1
    s_lshl_b32 s3, s3, 12
    s_add_u32 s3, s3, s5
    s_add_u32 s3, s3, 98304
    v_add_u32 v59, s3, v7
    s_mul_i32 s3, s32, 3
    s_add_u32 s3, s3, 1
    s_and_b32 s4, s3, 3
    s_lshr_b32 s5, s3, 2
    s_lshl_b32 s5, s5, 13
    v_xor_b32 v7, s4, v69
    v_lshl_add_u32 v7, v7, 5, v70
    s_xor_b32 s3, s31, 0
    s_lshl_b32 s3, s3, 12
    s_add_u32 s3, s3, s5
    s_add_u32 s3, s3, 16384
    v_add_u32 v60, s3, v7
    s_xor_b32 s3, s31, 0
    s_lshl_b32 s3, s3, 12
    s_add_u32 s3, s3, s5
    s_add_u32 s3, s3, 98304
    v_add_u32 v61, s3, v7
    s_xor_b32 s3, s31, 1
    s_lshl_b32 s3, s3, 12
    s_add_u32 s3, s3, s5
    s_add_u32 s3, s3, 16384
    v_add_u32 v62, s3, v7
    s_xor_b32 s3, s31, 1
    s_lshl_b32 s3, s3, 12
    s_add_u32 s3, s3, s5
    s_add_u32 s3, s3, 98304
    v_add_u32 v63, s3, v7
    s_mul_i32 s3, s32, 3
    s_add_u32 s3, s3, 2
    s_and_b32 s4, s3, 3
    s_lshr_b32 s5, s3, 2
    s_lshl_b32 s5, s5, 13
    v_xor_b32 v7, s4, v69
    v_lshl_add_u32 v7, v7, 5, v70
    s_xor_b32 s3, s31, 0
    s_lshl_b32 s3, s3, 12
    s_add_u32 s3, s3, s5
    s_add_u32 s3, s3, 16384
    v_add_u32 v64, s3, v7
    s_xor_b32 s3, s31, 0
    s_lshl_b32 s3, s3, 12
    s_add_u32 s3, s3, s5
    s_add_u32 s3, s3, 98304
    v_add_u32 v65, s3, v7
    s_xor_b32 s3, s31, 1
    s_lshl_b32 s3, s3, 12
    s_add_u32 s3, s3, s5
    s_add_u32 s3, s3, 16384
    v_add_u32 v66, s3, v7
    s_xor_b32 s3, s31, 1
    s_lshl_b32 s3, s3, 12
    s_add_u32 s3, s3, s5
    s_add_u32 s3, s3, 98304
    v_add_u32 v67, s3, v7
    s_add_u32 s48, s1, 1
    s_and_b32 s48, s48, 7
    s_lshl_b32 s49, s48, 7
    s_mul_i32 s48, s48, 176128
    s_add_u32 m0, s37, 40960
    s_nop 0
    buffer_load_dwordx4 v10, s[8:11], s49 offen lds
    s_add_u32 m0, s37, 41984
    s_add_u32 s49, s49, 8192
    buffer_load_dwordx4 v10, s[8:11], s49 offen lds
    s_add_u32 m0, s38, 40960
    s_add_u32 s39, s34, s48
    buffer_load_dwordx4 v11, s[12:15], s39 offen lds
    s_add_u32 m0, s38, 49152
    s_add_u32 s39, s35, s48
    buffer_load_dwordx4 v11, s[12:15], s39 offen lds
    s_add_u32 m0, s38, 57344
    s_add_u32 s39, s36, s48
    buffer_load_dwordx4 v11, s[12:15], s39 offen lds
    v_mov_b32 v72, 0
    v_mov_b32 v73, 0
    v_mov_b32 v74, 0
    v_mov_b32 v75, 0
    v_mov_b32 v76, 0
    v_mov_b32 v77, 0
    v_mov_b32 v78, 0
    v_mov_b32 v79, 0
    v_mov_b32 v80, 0
    v_mov_b32 v81, 0
    v_mov_b32 v82, 0
    v_mov_b32 v83, 0
    v_mov_b32 v84, 0
    v_mov_b32 v85, 0
    v_mov_b32 v86, 0
    v_mov_b32 v87, 0
    v_mov_b32 v88, 0
    v_mov_b32 v89, 0
    v_mov_b32 v90, 0
    v_mov_b32 v91, 0
    v_mov_b32 v92, 0
    v_mov_b32 v93, 0
    v_mov_b32 v94, 0
    v_mov_b32 v95, 0
    v_mov_b32 v96, 0
    v_mov_b32 v97, 0
    v_mov_b32 v98, 0
    v_mov_b32 v99, 0
    v_mov_b32 v100, 0
    v_mov_b32 v101, 0
    v_mov_b32 v102, 0
    v_mov_b32 v103, 0
    v_mov_b32 v104, 0
    v_mov_b32 v105, 0
    v_mov_b32 v106, 0
    v_mov_b32 v107, 0
    v_mov_b32 v108, 0
    v_mov_b32 v109, 0
    v_mov_b32 v110, 0
    v_mov_b32 v111, 0
    v_mov_b32 v112, 0
    v_mov_b32 v113, 0
    v_mov_b32 v114, 0
    v_mov_b32 v115, 0
    v_mov_b32 v116, 0
    v_mov_b32 v117, 0
    v_mov_b32 v118, 0
    v_mov_b32 v119, 0
    v_mov_b32 v176, 0
    v_mov_b32 v177, 0
    v_mov_b32 v178, 0
    v_mov_b32 v179, 0
    v_mov_b32 v180, 0
    v_mov_b32 v181, 0
    v_mov_b32 v182, 0
    v_mov_b32 v183, 0
    v_mov_b32 v184, 0
    v_mov_b32 v185, 0
    v_mov_b32 v186, 0
    v_mov_b32 v187, 0
    v_mov_b32 v188, 0x3f803f80
    v_mov_b32 v189, 0x3f803f80
    v_mov_b32 v190, 0x3f803f80
    v_mov_b32 v191, 0x3f803f80
    s_waitcnt vmcnt(5)
    s_barrier
    ds_read_b64_tr_b16 v[152:153], v56 offset:0
    ds_read_b64_tr_b16 v[154:155], v56 offset:512
    ds_read_b128 v[120:123], v40 offset:0
    ds_read_b128 v[124:127], v41 offset:0
    ds_read_b128 v[128:131], v42 offset:0
    ds_read_b128 v[132:135], v43 offset:0
    ds_read_b64_tr_b16 v[156:157], v60 offset:0
    ds_read_b64_tr_b16 v[158:159], v60 offset:512
    ds_read_b64_tr_b16 v[160:161], v64 offset:0
    ds_read_b64_tr_b16 v[162:163], v64 offset:512
    s_waitcnt lgkmcnt(0)
    v_mfma_f32_16x16x32_bf16 v[72:75], v[152:155], v[120:123], v[72:75]
    ds_read_b64_tr_b16 v[164:165], v58 offset:0
    ds_read_b64_tr_b16 v[166:167], v58 offset:512
    ds_read_b128 v[136:139], v44 offset:0
    v_mfma_f32_16x16x32_bf16 v[76:79], v[152:155], v[124:127], v[76:79]
    ds_read_b128 v[140:143], v45 offset:0
    ds_read_b128 v[144:147], v46 offset:0
    ds_read_b128 v[148:151], v47 offset:0
    v_mfma_f32_16x16x32_bf16 v[80:83], v[152:155], v[128:131], v[80:83]
    ds_read_b64_tr_b16 v[168:169], v62 offset:0
    ds_read_b64_tr_b16 v[170:171], v62 offset:512
    ds_read_b64_tr_b16 v[172:173], v66 offset:0
    v_mfma_f32_16x16x32_bf16 v[84:87], v[152:155], v[132:135], v[84:87]
    ds_read_b64_tr_b16 v[174:175], v66 offset:512
    s_add_u32 s48, s1, 2
    s_and_b32 s48, s48, 7
    v_mfma_f32_16x16x32_bf16 v[176:179], v[152:155], v[188:191], v[176:179]
    s_lshl_b32 s49, s48, 7
    s_mul_i32 s48, s48, 176128
    s_add_u32 m0, s37, 81920
    v_mfma_f32_16x16x32_bf16 v[88:91], v[156:159], v[120:123], v[88:91]
    buffer_load_dwordx4 v10, s[8:11], s49 offen lds
    s_add_u32 m0, s37, 82944
    s_add_u32 s49, s49, 8192
    v_mfma_f32_16x16x32_bf16 v[92:95], v[156:159], v[124:127], v[92:95]
    buffer_load_dwordx4 v10, s[8:11], s49 offen lds
    s_add_u32 m0, s38, 81920
    s_add_u32 s39, s34, s48
    v_mfma_f32_16x16x32_bf16 v[96:99], v[156:159], v[128:131], v[96:99]
    buffer_load_dwordx4 v11, s[12:15], s39 offen lds
    s_add_u32 m0, s38, 90112
    s_add_u32 s39, s35, s48
    v_mfma_f32_16x16x32_bf16 v[100:103], v[156:159], v[132:135], v[100:103]
    buffer_load_dwordx4 v11, s[12:15], s39 offen lds
    s_add_u32 m0, s38, 98304
    s_add_u32 s39, s36, s48
    v_mfma_f32_16x16x32_bf16 v[180:183], v[156:159], v[188:191], v[180:183]
    buffer_load_dwordx4 v11, s[12:15], s39 offen lds
    v_lshlrev_b32 v28, 16, v20
    v_and_b32 v29, 0xffff0000, v20
    v_mfma_f32_16x16x32_bf16 v[104:107], v[160:163], v[120:123], v[104:107]
    v_lshlrev_b32 v30, 16, v24
    v_and_b32 v31, 0xffff0000, v24
    v_mov_b32 v32, v28
    v_mfma_f32_16x16x32_bf16 v[108:111], v[160:163], v[124:127], v[108:111]
    v_mov_b32 v33, v29
    v_mul_f32 v34, v28, v28
    v_mul_f32 v35, v29, v29
    v_mfma_f32_16x16x32_bf16 v[112:115], v[160:163], v[128:131], v[112:115]
    v_mul_f32 v36, v28, v30
    v_mul_f32 v37, v29, v31
    v_lshlrev_b32 v28, 16, v21
    v_mfma_f32_16x16x32_bf16 v[116:119], v[160:163], v[132:135], v[116:119]
    v_and_b32 v29, 0xffff0000, v21
    v_lshlrev_b32 v30, 16, v25
    v_and_b32 v31, 0xffff0000, v25
    v_mfma_f32_16x16x32_bf16 v[184:187], v[160:163], v[188:191], v[184:187]
    v_add_f32 v32, v32, v28
    v_add_f32 v33, v33, v29
    v_fma_f32 v34, v28, v28, v34
    v_fma_f32 v35, v29, v29, v35
    v_fma_f32 v36, v28, v30, v36
    v_fma_f32 v37, v29, v31, v37
    v_lshlrev_b32 v28, 16, v22
    v_and_b32 v29, 0xffff0000, v22
    v_lshlrev_b32 v30, 16, v26
    v_and_b32 v31, 0xffff0000, v26
    v_add_f32 v32, v32, v28
    v_add_f32 v33, v33, v29
    v_fma_f32 v34, v28, v28, v34
    v_fma_f32 v35, v29, v29, v35
    v_fma_f32 v36, v28, v30, v36
    v_fma_f32 v37, v29, v31, v37
    s_waitcnt vmcnt(5) lgkmcnt(0)
    s_barrier
    v_mfma_f32_16x16x32_bf16 v[72:75], v[164:167], v[136:139], v[72:75]
    ds_read_b64_tr_b16 v[152:153], v56 offset:40960
    ds_read_b64_tr_b16 v[154:155], v56 offset:41472
    ds_read_b128 v[120:123], v40 offset:40960
    v_mfma_f32_16x16x32_bf16 v[76:79], v[164:167], v[140:143], v[76:79]
    ds_read_b128 v[124:127], v41 offset:40960
    ds_read_b128 v[128:131], v42 offset:40960
    ds_read_b128 v[132:135], v43 offset:40960
    v_mfma_f32_16x16x32_bf16 v[80:83], v[164:167], v[144:147], v[80:83]
    ds_read_b64_tr_b16 v[156:157], v60 offset:40960
    ds_read_b64_tr_b16 v[158:159], v60 offset:41472
    ds_read_b64_tr_b16 v[160:161], v64 offset:40960
    v_mfma_f32_16x16x32_bf16 v[84:87], v[164:167], v[148:151], v[84:87]
    ds_read_b64_tr_b16 v[162:163], v64 offset:41472
    s_add_u32 s48, s1, 3
    s_and_b32 s48, s48, 7
    v_mfma_f32_16x16x32_bf16 v[88:91], v[168:171], v[136:139], v[88:91]
    s_lshl_b32 s49, s48, 7
    s_mul_i32 s48, s48, 176128
    s_add_u32 m0, s37, 122880
    v_mfma_f32_16x16x32_bf16 v[92:95], v[168:171], v[140:143], v[92:95]
    buffer_load_dwordx4 v10, s[8:11], s49 offen lds
    s_add_u32 m0, s37, 123904
    s_add_u32 s49, s49, 8192
    v_mfma_f32_16x16x32_bf16 v[96:99], v[168:171], v[144:147], v[96:99]
    buffer_load_dwordx4 v10, s[8:11], s49 offen lds
    s_add_u32 m0, s38, 122880
    s_add_u32 s39, s34, s48
    v_mfma_f32_16x16x32_bf16 v[100:103], v[168:171], v[148:151], v[100:103]
    buffer_load_dwordx4 v11, s[12:15], s39 offen lds
    s_add_u32 m0, s38, 131072
    s_add_u32 s39, s35, s48
    v_mfma_f32_16x16x32_bf16 v[104:107], v[172:175], v[136:139], v[104:107]
    buffer_load_dwordx4 v11, s[12:15], s39 offen lds
    s_add_u32 m0, s38, 139264
    s_add_u32 s39, s36, s48
    v_mfma_f32_16x16x32_bf16 v[108:111], v[172:175], v[140:143], v[108:111]
    buffer_load_dwordx4 v11, s[12:15], s39 offen lds
    s_add_u32 s48, s1, 4
    s_and_b32 s48, s48, 7
    v_mfma_f32_16x16x32_bf16 v[112:115], v[172:175], v[144:147], v[112:115]
    s_lshl_b32 s49, s48, 7
    s_mul_i32 s48, s48, 176128
    s_add_u32 m0, s37, 0
    v_mfma_f32_16x16x32_bf16 v[116:119], v[172:175], v[148:151], v[116:119]
    buffer_load_dwordx4 v10, s[8:11], s49 offen lds
    s_add_u32 m0, s37, 1024
    s_add_u32 s49, s49, 8192
    buffer_load_dwordx4 v10, s[8:11], s49 offen lds
    s_add_u32 m0, s38, 0
    s_add_u32 s39, s34, s48
    buffer_load_dwordx4 v11, s[12:15], s39 offen lds
    s_add_u32 m0, s38, 8192
    s_add_u32 s39, s35, s48
    buffer_load_dwordx4 v11, s[12:15], s39 offen lds
    s_add_u32 m0, s38, 16384
    s_add_u32 s39, s36, s48
    buffer_load_dwordx4 v11, s[12:15], s39 offen lds
    v_lshlrev_b32 v28, 16, v23
    v_and_b32 v29, 0xffff0000, v23
    v_lshlrev_b32 v30, 16, v27
    v_and_b32 v31, 0xffff0000, v27
    v_add_f32 v32, v32, v28
    v_add_f32 v33, v33, v29
    v_fma_f32 v34, v28, v28, v34
    v_fma_f32 v35, v29, v29, v35
    v_fma_f32 v36, v28, v30, v36
    v_fma_f32 v37, v29, v31, v37
    v_add_f32 v32, v32, v33
    v_add_f32 v34, v34, v35
    v_add_f32 v36, v36, v37
    v_add_f32_dpp v32, v32, v32 row_ror:8 row_mask:0xf bank_mask:0xf
    v_add_f32_dpp v34, v34, v34 row_ror:8 row_mask:0xf bank_mask:0xf
    v_add_f32_dpp v36, v36, v36 row_ror:8 row_mask:0xf bank_mask:0xf
    v_add_f32_dpp v32, v32, v32 row_ror:4 row_mask:0xf bank_mask:0xf
    v_add_f32_dpp v34, v34, v34 row_ror:4 row_mask:0xf bank_mask:0xf
    v_add_f32_dpp v36, v36, v36 row_ror:4 row_mask:0xf bank_mask:0xf
    v_add_f32_dpp v32, v32, v32 row_ror:2 row_mask:0xf bank_mask:0xf
    v_add_f32_dpp v34, v34, v34 row_ror:2 row_mask:0xf bank_mask:0xf
    v_add_f32_dpp v36, v36, v36 row_ror:2 row_mask:0xf bank_mask:0xf
    v_add_f32_dpp v32, v32, v32 row_ror:1 row_mask:0xf bank_mask:0xf
    v_add_f32_dpp v34, v34, v34 row_ror:1 row_mask:0xf bank_mask:0xf
    v_add_f32_dpp v36, v36, v36 row_ror:1 row_mask:0xf bank_mask:0xf
    s_nop 0
    v_permlane32_swap_b32 v32, v34
    v_add_f32 v28, v32, v34
    v_mov_b32 v29, v28
    s_nop 1
    v_permlane16_swap_b32 v28, v29
    v_add_f32 v32, v28, v29
    s_waitcnt lgkmcnt(0)
    v_mfma_f32_16x16x32_bf16 v[72:75], v[152:155], v[120:123], v[72:75]
    ds_read_b64_tr_b16 v[164:165], v58 offset:40960
    ds_read_b64_tr_b16 v[166:167], v58 offset:41472
    ds_read_b128 v[136:139], v44 offset:40960
    v_mfma_f32_16x16x32_bf16 v[76:79], v[152:155], v[124:127], v[76:79]
    ds_read_b128 v[140:143], v45 offset:40960
    ds_read_b128 v[144:147], v46 offset:40960
    ds_read_b128 v[148:151], v47 offset:40960
    v_mfma_f32_16x16x32_bf16 v[80:83], v[152:155], v[128:131], v[80:83]
    ds_read_b64_tr_b16 v[168:169], v62 offset:40960
    ds_read_b64_tr_b16 v[170:171], v62 offset:41472
    ds_read_b64_tr_b16 v[172:173], v66 offset:40960
    v_mfma_f32_16x16x32_bf16 v[84:87], v[152:155], v[132:135], v[84:87]
    ds_read_b64_tr_b16 v[174:175], v66 offset:41472
    v_mov_b32 v34, v32
    s_nop 1
    v_permlane32_swap_b32 v32, v34
    v_mfma_f32_16x16x32_bf16 v[176:179], v[152:155], v[188:191], v[176:179]
    v_mov_b32 v30, v36
    s_nop 1
    v_permlane32_swap_b32 v36, v30
    v_add_f32 v36, v36, v30
    v_mfma_f32_16x16x32_bf16 v[88:91], v[156:159], v[120:123], v[88:91]
    v_mov_b32 v30, v36
    s_nop 1
    v_permlane16_swap_b32 v36, v30
    v_add_f32 v36, v36, v30
    v_mfma_f32_16x16x32_bf16 v[92:95], v[156:159], v[124:127], v[92:95]
    v_mul_f32 v32, 0x3b000000, v32
    v_mul_f32 v28, v32, v32
    v_mul_f32 v34, 0x3b000000, v34
    v_mfma_f32_16x16x32_bf16 v[96:99], v[156:159], v[128:131], v[96:99]
    v_sub_f32 v34, v34, v28
    v_max_f32 v34, 0, v34
    v_add_f32 v34, 0x3727c5ac, v34
    v_mfma_f32_16x16x32_bf16 v[100:103], v[156:159], v[132:135], v[100:103]
    v_mul_f32 v36, 0xbfb8aa3b, v36
    v_rsq_f32 v28, v34
    v_exp_f32 v36, v36
    v_mfma_f32_16x16x32_bf16 v[180:183], v[156:159], v[188:191], v[180:183]
    v_mov_b32 v31, 0
    v_mul_f32 v29, v28, v32
    v_add_f32 v36, 1.0, v36
    v_mfma_f32_16x16x32_bf16 v[104:107], v[160:163], v[120:123], v[104:107]
    v_rcp_f32 v30, v36
    v_mov_b32 v33, s101
    v_mfma_f32_16x16x32_bf16 v[108:111], v[160:163], v[124:127], v[108:111]
    v_mfma_f32_16x16x32_bf16 v[112:115], v[160:163], v[128:131], v[112:115]
    v_mfma_f32_16x16x32_bf16 v[116:119], v[160:163], v[132:135], v[116:119]
    v_mfma_f32_16x16x32_bf16 v[184:187], v[160:163], v[188:191], v[184:187]
    s_mov_b64 s[6:7], exec
    s_mov_b64 exec, 1
    buffer_store_dwordx4 v[28:31], v33, s[16:19], 0 offen sc1
    s_mov_b64 exec, s[6:7]
    s_waitcnt vmcnt(10) lgkmcnt(0)
    s_barrier
    s_nop 1
    v_mfma_f32_16x16x32_bf16 v[72:75], v[164:167], v[136:139], v[72:75]
    ds_read_b64_tr_b16 v[152:153], v57 offset:0
    ds_read_b64_tr_b16 v[154:155], v57 offset:512
    ds_read_b128 v[120:123], v48 offset:0
    v_mfma_f32_16x16x32_bf16 v[76:79], v[164:167], v[140:143], v[76:79]
    ds_read_b128 v[124:127], v49 offset:0
    ds_read_b128 v[128:131], v50 offset:0
    ds_read_b128 v[132:135], v51 offset:0
    v_mfma_f32_16x16x32_bf16 v[80:83], v[164:167], v[144:147], v[80:83]
    ds_read_b64_tr_b16 v[156:157], v61 offset:0
    ds_read_b64_tr_b16 v[158:159], v61 offset:512
    ds_read_b64_tr_b16 v[160:161], v65 offset:0
    v_mfma_f32_16x16x32_bf16 v[84:87], v[164:167], v[148:151], v[84:87]
    ds_read_b64_tr_b16 v[162:163], v65 offset:512
    s_add_u32 s48, s1, 5
    s_and_b32 s48, s48, 7
    v_mfma_f32_16x16x32_bf16 v[88:91], v[168:171], v[136:139], v[88:91]
    s_lshl_b32 s49, s48, 7
    s_mul_i32 s48, s48, 176128
    s_add_u32 m0, s37, 40960
    v_mfma_f32_16x16x32_bf16 v[92:95], v[168:171], v[140:143], v[92:95]
    buffer_load_dwordx4 v10, s[8:11], s49 offen lds
    s_add_u32 m0, s37, 41984
    s_add_u32 s49, s49, 8192
    v_mfma_f32_16x16x32_bf16 v[96:99], v[168:171], v[144:147], v[96:99]
    buffer_load_dwordx4 v10, s[8:11], s49 offen lds
    s_add_u32 m0, s38, 40960
    s_add_u32 s39, s34, s48
    v_mfma_f32_16x16x32_bf16 v[100:103], v[168:171], v[148:151], v[100:103]
    buffer_load_dwordx4 v11, s[12:15], s39 offen lds
    s_add_u32 m0, s38, 49152
    s_add_u32 s39, s35, s48
    v_mfma_f32_16x16x32_bf16 v[104:107], v[172:175], v[136:139], v[104:107]
    buffer_load_dwordx4 v11, s[12:15], s39 offen lds
    s_add_u32 m0, s38, 57344
    s_add_u32 s39, s36, s48
    v_mfma_f32_16x16x32_bf16 v[108:111], v[172:175], v[140:143], v[108:111]
    buffer_load_dwordx4 v11, s[12:15], s39 offen lds
    s_mov_b32 s6, 1409024
    s_movk_i32 s3, 5504
    v_mfma_f32_16x16x32_bf16 v[112:115], v[172:175], v[144:147], v[112:115]
    s_cmp_ge_u32 s30, 6
    s_cselect_b32 s4, s46, s54
    s_cselect_b32 s5, s47, s55
    v_mfma_f32_16x16x32_bf16 v[116:119], v[172:175], v[148:151], v[116:119]
    s_cselect_b32 s6, 524288, s6
    s_mov_b32 s7, 0x00020000
    s_cselect_b32 s3, 2048, s3
    s_mul_i32 s3, s3, s2
    s_cselect_b32 s100, 6144, 0
    s_sub_u32 s3, s3, s100
    v_lshl_add_u32 v7, v0, 4, s3
    buffer_load_dwordx4 v[208:211], v7, s[4:7], 0 offen
    s_waitcnt lgkmcnt(0)
    v_mfma_f32_16x16x32_bf16 v[72:75], v[152:155], v[120:123], v[72:75]
    ds_read_b64_tr_b16 v[164:165], v59 offset:0
    ds_read_b64_tr_b16 v[166:167], v59 offset:512
    v_mfma_f32_16x16x32_bf16 v[76:79], v[152:155], v[124:127], v[76:79]
    ds_read_b128 v[136:139], v52 offset:0
    ds_read_b128 v[140:143], v53 offset:0
    v_mfma_f32_16x16x32_bf16 v[80:83], v[152:155], v[128:131], v[80:83]
    ds_read_b128 v[144:147], v54 offset:0
    ds_read_b128 v[148:151], v55 offset:0
    v_mfma_f32_16x16x32_bf16 v[84:87], v[152:155], v[132:135], v[84:87]
    ds_read_b64_tr_b16 v[168:169], v63 offset:0
    ds_read_b64_tr_b16 v[170:171], v63 offset:512
    v_mfma_f32_16x16x32_bf16 v[176:179], v[152:155], v[188:191], v[176:179]
    ds_read_b64_tr_b16 v[172:173], v67 offset:0
    ds_read_b64_tr_b16 v[174:175], v67 offset:512
    v_mfma_f32_16x16x32_bf16 v[88:91], v[156:159], v[120:123], v[88:91]
    v_mfma_f32_16x16x32_bf16 v[92:95], v[156:159], v[124:127], v[92:95]
    v_mfma_f32_16x16x32_bf16 v[96:99], v[156:159], v[128:131], v[96:99]
    v_mfma_f32_16x16x32_bf16 v[100:103], v[156:159], v[132:135], v[100:103]
    v_mfma_f32_16x16x32_bf16 v[180:183], v[156:159], v[188:191], v[180:183]
    v_mfma_f32_16x16x32_bf16 v[104:107], v[160:163], v[120:123], v[104:107]
    v_mfma_f32_16x16x32_bf16 v[108:111], v[160:163], v[124:127], v[108:111]
    v_mfma_f32_16x16x32_bf16 v[112:115], v[160:163], v[128:131], v[112:115]
    v_mfma_f32_16x16x32_bf16 v[116:119], v[160:163], v[132:135], v[116:119]
    v_mfma_f32_16x16x32_bf16 v[184:187], v[160:163], v[188:191], v[184:187]
    s_waitcnt vmcnt(11) lgkmcnt(0)
    s_barrier
    v_mfma_f32_16x16x32_bf16 v[72:75], v[164:167], v[136:139], v[72:75]
    ds_read_b64_tr_b16 v[152:153], v57 offset:40960
    ds_read_b64_tr_b16 v[154:155], v57 offset:41472
    ds_read_b128 v[120:123], v48 offset:40960
    v_mfma_f32_16x16x32_bf16 v[76:79], v[164:167], v[140:143], v[76:79]
    ds_read_b128 v[124:127], v49 offset:40960
    ds_read_b128 v[128:131], v50 offset:40960
    ds_read_b128 v[132:135], v51 offset:40960
    v_mfma_f32_16x16x32_bf16 v[80:83], v[164:167], v[144:147], v[80:83]
    ds_read_b64_tr_b16 v[156:157], v61 offset:40960
    ds_read_b64_tr_b16 v[158:159], v61 offset:41472
    ds_read_b64_tr_b16 v[160:161], v65 offset:40960
    v_mfma_f32_16x16x32_bf16 v[84:87], v[164:167], v[148:151], v[84:87]
    ds_read_b64_tr_b16 v[162:163], v65 offset:41472
    s_add_u32 s48, s1, 6
    s_and_b32 s48, s48, 7
    v_mfma_f32_16x16x32_bf16 v[88:91], v[168:171], v[136:139], v[88:91]
    s_lshl_b32 s49, s48, 7
    s_mul_i32 s48, s48, 176128
    s_add_u32 m0, s37, 81920
    v_mfma_f32_16x16x32_bf16 v[92:95], v[168:171], v[140:143], v[92:95]
    buffer_load_dwordx4 v10, s[8:11], s49 offen lds
    s_add_u32 m0, s37, 82944
    s_add_u32 s49, s49, 8192
    v_mfma_f32_16x16x32_bf16 v[96:99], v[168:171], v[144:147], v[96:99]
    buffer_load_dwordx4 v10, s[8:11], s49 offen lds
    s_add_u32 m0, s38, 81920
    s_add_u32 s39, s34, s48
    v_mfma_f32_16x16x32_bf16 v[100:103], v[168:171], v[148:151], v[100:103]
    buffer_load_dwordx4 v11, s[12:15], s39 offen lds
    s_add_u32 m0, s38, 90112
    s_add_u32 s39, s35, s48
    v_mfma_f32_16x16x32_bf16 v[104:107], v[172:175], v[136:139], v[104:107]
    buffer_load_dwordx4 v11, s[12:15], s39 offen lds
    s_add_u32 m0, s38, 98304
    s_add_u32 s39, s36, s48
    v_mfma_f32_16x16x32_bf16 v[108:111], v[172:175], v[140:143], v[108:111]
    buffer_load_dwordx4 v11, s[12:15], s39 offen lds
    v_mfma_f32_16x16x32_bf16 v[112:115], v[172:175], v[144:147], v[112:115]
    v_mfma_f32_16x16x32_bf16 v[116:119], v[172:175], v[148:151], v[116:119]
    s_waitcnt lgkmcnt(0)
    v_mfma_f32_16x16x32_bf16 v[72:75], v[152:155], v[120:123], v[72:75]
    ds_read_b64_tr_b16 v[164:165], v59 offset:40960
    ds_read_b64_tr_b16 v[166:167], v59 offset:41472
    v_mfma_f32_16x16x32_bf16 v[76:79], v[152:155], v[124:127], v[76:79]
    ds_read_b128 v[136:139], v52 offset:40960
    ds_read_b128 v[140:143], v53 offset:40960
    v_mfma_f32_16x16x32_bf16 v[80:83], v[152:155], v[128:131], v[80:83]
    ds_read_b128 v[144:147], v54 offset:40960
    ds_read_b128 v[148:151], v55 offset:40960
    v_mfma_f32_16x16x32_bf16 v[84:87], v[152:155], v[132:135], v[84:87]
    ds_read_b64_tr_b16 v[168:169], v63 offset:40960
    ds_read_b64_tr_b16 v[170:171], v63 offset:41472
    v_mfma_f32_16x16x32_bf16 v[176:179], v[152:155], v[188:191], v[176:179]
    ds_read_b64_tr_b16 v[172:173], v67 offset:40960
    ds_read_b64_tr_b16 v[174:175], v67 offset:41472
    v_mfma_f32_16x16x32_bf16 v[88:91], v[156:159], v[120:123], v[88:91]
    v_mfma_f32_16x16x32_bf16 v[92:95], v[156:159], v[124:127], v[92:95]
    v_mfma_f32_16x16x32_bf16 v[96:99], v[156:159], v[128:131], v[96:99]
    v_mfma_f32_16x16x32_bf16 v[100:103], v[156:159], v[132:135], v[100:103]
    v_mfma_f32_16x16x32_bf16 v[180:183], v[156:159], v[188:191], v[180:183]
    v_mfma_f32_16x16x32_bf16 v[104:107], v[160:163], v[120:123], v[104:107]
    v_mfma_f32_16x16x32_bf16 v[108:111], v[160:163], v[124:127], v[108:111]
    v_mfma_f32_16x16x32_bf16 v[112:115], v[160:163], v[128:131], v[112:115]
    v_mfma_f32_16x16x32_bf16 v[116:119], v[160:163], v[132:135], v[116:119]
    v_mfma_f32_16x16x32_bf16 v[184:187], v[160:163], v[188:191], v[184:187]
    s_cmp_lg_u32 s30, 7
    s_cbranch_scc1 F_GOK1
    v_and_b32 v7, 7, v2
    v_lshlrev_b32 v7, 2, v7
    buffer_load_dword v8, v7, s[96:99], 0 offen offset:32
    s_waitcnt vmcnt(0)
    v_cmp_eq_u32 vcc, 1, v8
    s_nop 2
    s_cmp_eq_u64 vcc, -1
    s_cbranch_scc1 F_GOK1
    s_mov_b32 s4, 0
F_GSP1:
    buffer_load_dword v8, v7, s[96:99], 0 offen offset:32 sc0 sc1
    s_waitcnt vmcnt(0)
    v_cmp_eq_u32 vcc, 1, v8
    s_nop 2
    s_cmp_eq_u64 vcc, -1
    s_cbranch_scc1 F_GOK1
    s_add_u32 s4, s4, 1
    s_cmp_ge_u32 s4, 60000
    s_cbranch_scc1 F_GOK1
    s_sleep 8
    s_branch F_GSP1
F_GOK1:
    s_waitcnt vmcnt(11) lgkmcnt(0)
    s_barrier
    s_cmp_lg_u32 s30, 7
    s_cbranch_scc1 F_NOPRF1
    s_lshl_b32 s3, s28, 7
    s_lshl_b32 s4, s29, 2
    s_add_u32 s3, s3, s4
    s_add_u32 s3, s3, 13113376
    v_mov_b32 v7, s3
    v_mov_b32 v8, s0
    s_mov_b64 s[6:7], exec
    s_mov_b64 exec, 1
    buffer_store_dword v8, v7, s[16:19], 0 offen sc1
    s_mov_b64 exec, s[6:7]
F_NOPRF1:
    s_nop 3
    v_mfma_f32_16x16x32_bf16 v[72:75], v[164:167], v[136:139], v[72:75]
    ds_read_b64_tr_b16 v[152:153], v56 offset:0
    ds_read_b64_tr_b16 v[154:155], v56 offset:512
    ds_read_b128 v[120:123], v40 offset:0
    v_mfma_f32_16x16x32_bf16 v[76:79], v[164:167], v[140:143], v[76:79]
    ds_read_b128 v[124:127], v41 offset:0
    ds_read_b128 v[128:131], v42 offset:0
    ds_read_b128 v[132:135], v43 offset:0
    v_mfma_f32_16x16x32_bf16 v[80:83], v[164:167], v[144:147], v[80:83]
    ds_read_b64_tr_b16 v[156:157], v60 offset:0
    ds_read_b64_tr_b16 v[158:159], v60 offset:512
    ds_read_b64_tr_b16 v[160:161], v64 offset:0
    v_mfma_f32_16x16x32_bf16 v[84:87], v[164:167], v[148:151], v[84:87]
    ds_read_b64_tr_b16 v[162:163], v64 offset:512
    s_add_u32 s48, s1, 7
    s_and_b32 s48, s48, 7
    v_mfma_f32_16x16x32_bf16 v[88:91], v[168:171], v[136:139], v[88:91]
    s_lshl_b32 s49, s48, 7
    s_mul_i32 s48, s48, 176128
    s_add_u32 m0, s37, 122880
    v_mfma_f32_16x16x32_bf16 v[92:95], v[168:171], v[140:143], v[92:95]
    buffer_load_dwordx4 v10, s[8:11], s49 offen lds
    s_add_u32 m0, s37, 123904
    s_add_u32 s49, s49, 8192
    v_mfma_f32_16x16x32_bf16 v[96:99], v[168:171], v[144:147], v[96:99]
    buffer_load_dwordx4 v10, s[8:11], s49 offen lds
    s_add_u32 m0, s38, 122880
    s_add_u32 s39, s34, s48
    v_mfma_f32_16x16x32_bf16 v[100:103], v[168:171], v[148:151], v[100:103]
    buffer_load_dwordx4 v11, s[12:15], s39 offen lds
    s_add_u32 m0, s38, 131072
    s_add_u32 s39, s35, s48
    v_mfma_f32_16x16x32_bf16 v[104:107], v[172:175], v[136:139], v[104:107]
    buffer_load_dwordx4 v11, s[12:15], s39 offen lds
    s_add_u32 m0, s38, 139264
    s_add_u32 s39, s36, s48
    v_mfma_f32_16x16x32_bf16 v[108:111], v[172:175], v[140:143], v[108:111]
    buffer_load_dwordx4 v11, s[12:15], s39 offen lds
    v_mfma_f32_16x16x32_bf16 v[112:115], v[172:175], v[144:147], v[112:115]
    v_mfma_f32_16x16x32_bf16 v[116:119], v[172:175], v[148:151], v[116:119]
    s_waitcnt lgkmcnt(0)
    v_mfma_f32_16x16x32_bf16 v[72:75], v[152:155], v[120:123], v[72:75]
    ds_read_b64_tr_b16 v[164:165], v58 offset:0
    ds_read_b64_tr_b16 v[166:167], v58 offset:512
    v_mfma_f32_16x16x32_bf16 v[76:79], v[152:155], v[124:127], v[76:79]
    ds_read_b128 v[136:139], v44 offset:0
    ds_read_b128 v[140:143], v45 offset:0
    v_mfma_f32_16x16x32_bf16 v[80:83], v[152:155], v[128:131], v[80:83]
    ds_read_b128 v[144:147], v46 offset:0
    ds_read_b128 v[148:151], v47 offset:0
    v_mfma_f32_16x16x32_bf16 v[84:87], v[152:155], v[132:135], v[84:87]
    ds_read_b64_tr_b16 v[168:169], v62 offset:0
    ds_read_b64_tr_b16 v[170:171], v62 offset:512
    v_mfma_f32_16x16x32_bf16 v[176:179], v[152:155], v[188:191], v[176:179]
    ds_read_b64_tr_b16 v[172:173], v66 offset:0
    ds_read_b64_tr_b16 v[174:175], v66 offset:512
    v_mfma_f32_16x16x32_bf16 v[88:91], v[156:159], v[120:123], v[88:91]
    v_mfma_f32_16x16x32_bf16 v[92:95], v[156:159], v[124:127], v[92:95]
    v_mfma_f32_16x16x32_bf16 v[96:99], v[156:159], v[128:131], v[96:99]
    v_mfma_f32_16x16x32_bf16 v[100:103], v[156:159], v[132:135], v[100:103]
    v_mfma_f32_16x16x32_bf16 v[180:183], v[156:159], v[188:191], v[180:183]
    v_mfma_f32_16x16x32_bf16 v[104:107], v[160:163], v[120:123], v[104:107]
    v_mfma_f32_16x16x32_bf16 v[108:111], v[160:163], v[124:127], v[108:111]
    v_mfma_f32_16x16x32_bf16 v[112:115], v[160:163], v[128:131], v[112:115]
    v_mfma_f32_16x16x32_bf16 v[116:119], v[160:163], v[132:135], v[116:119]
    v_mfma_f32_16x16x32_bf16 v[184:187], v[160:163], v[188:191], v[184:187]
    s_waitcnt vmcnt(11) lgkmcnt(0)
    s_barrier
    v_mfma_f32_16x16x32_bf16 v[72:75], v[164:167], v[136:139], v[72:75]
    ds_read_b64_tr_b16 v[152:153], v56 offset:40960
    ds_read_b64_tr_b16 v[154:155], v56 offset:41472
    ds_read_b128 v[120:123], v40 offset:40960
    v_mfma_f32_16x16x32_bf16 v[76:79], v[164:167], v[140:143], v[76:79]
    ds_read_b128 v[124:127], v41 offset:40960
    ds_read_b128 v[128:131], v42 offset:40960
    ds_read_b128 v[132:135], v43 offset:40960
    v_mfma_f32_16x16x32_bf16 v[80:83], v[164:167], v[144:147], v[80:83]
    ds_read_b64_tr_b16 v[156:157], v60 offset:40960
    ds_read_b64_tr_b16 v[158:159], v60 offset:41472
    ds_read_b64_tr_b16 v[160:161], v64 offset:40960
    v_mfma_f32_16x16x32_bf16 v[84:87], v[164:167], v[148:151], v[84:87]
    ds_read_b64_tr_b16 v[162:163], v64 offset:41472
    s_mov_b32 s8, s54
    s_mov_b32 s9, s55
    v_mfma_f32_16x16x32_bf16 v[88:91], v[168:171], v[136:139], v[88:91]
    s_mov_b32 s10, 1409024
    s_mov_b32 s11, 0x00020000
    s_mov_b32 s12, s46
    v_mfma_f32_16x16x32_bf16 v[92:95], v[168:171], v[140:143], v[92:95]
    s_mov_b32 s13, s47
    s_mov_b32 s14, 524288
    s_mov_b32 s15, 0x00020000
    v_mfma_f32_16x16x32_bf16 v[96:99], v[168:171], v[144:147], v[96:99]
    s_lshl_b32 s34, s30, 12
    s_lshr_b32 s35, s30, 1
    s_mul_i32 s35, s35, 40960
    v_mfma_f32_16x16x32_bf16 v[100:103], v[168:171], v[148:151], v[100:103]
    s_and_b32 s36, s30, 1
    s_lshl_b32 s36, s36, 12
    s_add_u32 s35, s35, s36
    v_mfma_f32_16x16x32_bf16 v[104:107], v[172:175], v[136:139], v[104:107]
    s_add_u32 s35, s35, 32768
    s_mul_i32 s36, s30, 49152
    s_lshl_b32 s38, s30, 16
    v_mfma_f32_16x16x32_bf16 v[108:111], v[172:175], v[140:143], v[108:111]
    s_add_u32 m0, s34, 0
    s_add_u32 s39, s38, 0
    buffer_load_dwordx4 v12, s[12:15], s39 offen lds
    v_mfma_f32_16x16x32_bf16 v[112:115], v[172:175], v[144:147], v[112:115]
    s_add_u32 m0, s34, 1024
    s_add_u32 s39, s38, 8192
    buffer_load_dwordx4 v12, s[12:15], s39 offen lds
    v_mfma_f32_16x16x32_bf16 v[116:119], v[172:175], v[148:151], v[116:119]
    s_add_u32 m0, s34, 2048
    s_add_u32 s39, s38, 16384
    buffer_load_dwordx4 v12, s[12:15], s39 offen lds
    s_add_u32 m0, s34, 3072
    s_add_u32 s39, s38, 24576
    buffer_load_dwordx4 v12, s[12:15], s39 offen lds
    s_waitcnt lgkmcnt(0)
    v_mfma_f32_16x16x32_bf16 v[72:75], v[152:155], v[120:123], v[72:75]
    ds_read_b64_tr_b16 v[164:165], v58 offset:40960
    ds_read_b64_tr_b16 v[166:167], v58 offset:41472
    v_mfma_f32_16x16x32_bf16 v[76:79], v[152:155], v[124:127], v[76:79]
    ds_read_b128 v[136:139], v44 offset:40960
    ds_read_b128 v[140:143], v45 offset:40960
    v_mfma_f32_16x16x32_bf16 v[80:83], v[152:155], v[128:131], v[80:83]
    ds_read_b128 v[144:147], v46 offset:40960
    ds_read_b128 v[148:151], v47 offset:40960
    v_mfma_f32_16x16x32_bf16 v[84:87], v[152:155], v[132:135], v[84:87]
    ds_read_b64_tr_b16 v[168:169], v62 offset:40960
    ds_read_b64_tr_b16 v[170:171], v62 offset:41472
    v_mfma_f32_16x16x32_bf16 v[176:179], v[152:155], v[188:191], v[176:179]
    ds_read_b64_tr_b16 v[172:173], v66 offset:40960
    ds_read_b64_tr_b16 v[174:175], v66 offset:41472
    v_mfma_f32_16x16x32_bf16 v[88:91], v[156:159], v[120:123], v[88:91]
    v_mfma_f32_16x16x32_bf16 v[92:95], v[156:159], v[124:127], v[92:95]
    v_mfma_f32_16x16x32_bf16 v[96:99], v[156:159], v[128:131], v[96:99]
    v_mfma_f32_16x16x32_bf16 v[100:103], v[156:159], v[132:135], v[100:103]
    v_mfma_f32_16x16x32_bf16 v[180:183], v[156:159], v[188:191], v[180:183]
    v_mfma_f32_16x16x32_bf16 v[104:107], v[160:163], v[120:123], v[104:107]
    v_mfma_f32_16x16x32_bf16 v[108:111], v[160:163], v[124:127], v[108:111]
    v_mfma_f32_16x16x32_bf16 v[112:115], v[160:163], v[128:131], v[112:115]
    v_mfma_f32_16x16x32_bf16 v[116:119], v[160:163], v[132:135], v[116:119]
    v_mfma_f32_16x16x32_bf16 v[184:187], v[160:163], v[188:191], v[184:187]
    s_waitcnt vmcnt(9) lgkmcnt(0)
    s_barrier
    v_mfma_f32_16x16x32_bf16 v[72:75], v[164:167], v[136:139], v[72:75]
    ds_read_b64_tr_b16 v[152:153], v57 offset:0
    ds_read_b64_tr_b16 v[154:155], v57 offset:512
    ds_read_b128 v[120:123], v48 offset:0
    v_mfma_f32_16x16x32_bf16 v[76:79], v[164:167], v[140:143], v[76:79]
    ds_read_b128 v[124:127], v49 offset:0
    ds_read_b128 v[128:131], v50 offset:0
    ds_read_b128 v[132:135], v51 offset:0
    v_mfma_f32_16x16x32_bf16 v[80:83], v[164:167], v[144:147], v[80:83]
    ds_read_b64_tr_b16 v[156:157], v61 offset:0
    ds_read_b64_tr_b16 v[158:159], v61 offset:512
    ds_read_b64_tr_b16 v[160:161], v65 offset:0
    v_mfma_f32_16x16x32_bf16 v[84:87], v[164:167], v[148:151], v[84:87]
    ds_read_b64_tr_b16 v[162:163], v65 offset:512
    s_add_u32 m0, s34, 40960
    s_add_u32 s39, s38, 32768
    v_mfma_f32_16x16x32_bf16 v[88:91], v[168:171], v[136:139], v[88:91]
    buffer_load_dwordx4 v12, s[12:15], s39 offen lds
    s_add_u32 m0, s34, 41984
    s_add_u32 s39, s38, 40960
    v_mfma_f32_16x16x32_bf16 v[92:95], v[168:171], v[140:143], v[92:95]
    buffer_load_dwordx4 v12, s[12:15], s39 offen lds
    s_add_u32 m0, s34, 43008
    s_add_u32 s39, s38, 49152
    v_mfma_f32_16x16x32_bf16 v[96:99], v[168:171], v[144:147], v[96:99]
    buffer_load_dwordx4 v12, s[12:15], s39 offen lds
    s_add_u32 m0, s34, 44032
    s_add_u32 s39, s38, 57344
    v_mfma_f32_16x16x32_bf16 v[100:103], v[168:171], v[148:151], v[100:103]
    buffer_load_dwordx4 v12, s[12:15], s39 offen lds
    v_mfma_f32_16x16x32_bf16 v[104:107], v[172:175], v[136:139], v[104:107]
    v_mfma_f32_16x16x32_bf16 v[108:111], v[172:175], v[140:143], v[108:111]
    v_mfma_f32_16x16x32_bf16 v[112:115], v[172:175], v[144:147], v[112:115]
    v_mfma_f32_16x16x32_bf16 v[116:119], v[172:175], v[148:151], v[116:119]
    s_waitcnt lgkmcnt(0)
    v_mfma_f32_16x16x32_bf16 v[72:75], v[152:155], v[120:123], v[72:75]
    ds_read_b64_tr_b16 v[164:165], v59 offset:0
    ds_read_b64_tr_b16 v[166:167], v59 offset:512
    v_mfma_f32_16x16x32_bf16 v[76:79], v[152:155], v[124:127], v[76:79]
    ds_read_b128 v[136:139], v52 offset:0
    ds_read_b128 v[140:143], v53 offset:0
    v_mfma_f32_16x16x32_bf16 v[80:83], v[152:155], v[128:131], v[80:83]
    ds_read_b128 v[144:147], v54 offset:0
    ds_read_b128 v[148:151], v55 offset:0
    v_mfma_f32_16x16x32_bf16 v[84:87], v[152:155], v[132:135], v[84:87]
    ds_read_b64_tr_b16 v[168:169], v63 offset:0
    ds_read_b64_tr_b16 v[170:171], v63 offset:512
    v_mfma_f32_16x16x32_bf16 v[176:179], v[152:155], v[188:191], v[176:179]
    ds_read_b64_tr_b16 v[172:173], v67 offset:0
    ds_read_b64_tr_b16 v[174:175], v67 offset:512
    v_mfma_f32_16x16x32_bf16 v[88:91], v[156:159], v[120:123], v[88:91]
    v_mfma_f32_16x16x32_bf16 v[92:95], v[156:159], v[124:127], v[92:95]
    v_mfma_f32_16x16x32_bf16 v[96:99], v[156:159], v[128:131], v[96:99]
    v_mfma_f32_16x16x32_bf16 v[100:103], v[156:159], v[132:135], v[100:103]
    v_mfma_f32_16x16x32_bf16 v[180:183], v[156:159], v[188:191], v[180:183]
    v_mfma_f32_16x16x32_bf16 v[104:107], v[160:163], v[120:123], v[104:107]
    v_mfma_f32_16x16x32_bf16 v[108:111], v[160:163], v[124:127], v[108:111]
    v_mfma_f32_16x16x32_bf16 v[112:115], v[160:163], v[128:131], v[112:115]
    v_mfma_f32_16x16x32_bf16 v[116:119], v[160:163], v[132:135], v[116:119]
    v_mfma_f32_16x16x32_bf16 v[184:187], v[160:163], v[188:191], v[184:187]
    s_waitcnt vmcnt(8) lgkmcnt(0)
    s_barrier
    v_mfma_f32_16x16x32_bf16 v[72:75], v[164:167], v[136:139], v[72:75]
    ds_read_b64_tr_b16 v[152:153], v57 offset:40960
    ds_read_b64_tr_b16 v[154:155], v57 offset:41472
    ds_read_b128 v[120:123], v48 offset:40960
    v_mfma_f32_16x16x32_bf16 v[76:79], v[164:167], v[140:143], v[76:79]
    ds_read_b128 v[124:127], v49 offset:40960
    ds_read_b128 v[128:131], v50 offset:40960
    ds_read_b128 v[132:135], v51 offset:40960
    v_mfma_f32_16x16x32_bf16 v[80:83], v[164:167], v[144:147], v[80:83]
    ds_read_b64_tr_b16 v[156:157], v61 offset:40960
    ds_read_b64_tr_b16 v[158:159], v61 offset:41472
    ds_read_b64_tr_b16 v[160:161], v65 offset:40960
    v_mfma_f32_16x16x32_bf16 v[84:87], v[164:167], v[148:151], v[84:87]
    ds_read_b64_tr_b16 v[162:163], v65 offset:41472
    s_add_u32 m0, s34, 81920
    s_add_u32 s39, s36, 1032192
    v_mfma_f32_16x16x32_bf16 v[88:91], v[168:171], v[136:139], v[88:91]
    buffer_load_dwordx4 v12, s[8:11], s39 offen lds
    s_add_u32 m0, s34, 82944
    s_add_u32 s39, s36, 1040384
    v_mfma_f32_16x16x32_bf16 v[92:95], v[168:171], v[140:143], v[92:95]
    buffer_load_dwordx4 v12, s[8:11], s39 offen lds
    s_add_u32 m0, s34, 83968
    s_add_u32 s39, s36, 1048576
    v_mfma_f32_16x16x32_bf16 v[96:99], v[168:171], v[144:147], v[96:99]
    buffer_load_dwordx4 v12, s[8:11], s39 offen lds
    s_add_u32 m0, s34, 84992
    s_add_u32 s39, s36, 1056768
    v_mfma_f32_16x16x32_bf16 v[100:103], v[168:171], v[148:151], v[100:103]
    buffer_load_dwordx4 v12, s[8:11], s39 offen lds
    v_mfma_f32_16x16x32_bf16 v[104:107], v[172:175], v[136:139], v[104:107]
    v_mfma_f32_16x16x32_bf16 v[108:111], v[172:175], v[140:143], v[108:111]
    v_mfma_f32_16x16x32_bf16 v[112:115], v[172:175], v[144:147], v[112:115]
    v_mfma_f32_16x16x32_bf16 v[116:119], v[172:175], v[148:151], v[116:119]
    s_waitcnt lgkmcnt(0)
    v_mfma_f32_16x16x32_bf16 v[72:75], v[152:155], v[120:123], v[72:75]
    ds_read_b64_tr_b16 v[164:165], v59 offset:40960
    ds_read_b64_tr_b16 v[166:167], v59 offset:41472
    v_mfma_f32_16x16x32_bf16 v[76:79], v[152:155], v[124:127], v[76:79]
    ds_read_b128 v[136:139], v52 offset:40960
    ds_read_b128 v[140:143], v53 offset:40960
    v_mfma_f32_16x16x32_bf16 v[80:83], v[152:155], v[128:131], v[80:83]
    ds_read_b128 v[144:147], v54 offset:40960
    ds_read_b128 v[148:151], v55 offset:40960
    v_mfma_f32_16x16x32_bf16 v[84:87], v[152:155], v[132:135], v[84:87]
    ds_read_b64_tr_b16 v[168:169], v63 offset:40960
    ds_read_b64_tr_b16 v[170:171], v63 offset:41472
    v_mfma_f32_16x16x32_bf16 v[176:179], v[152:155], v[188:191], v[176:179]
    ds_read_b64_tr_b16 v[172:173], v67 offset:40960
    ds_read_b64_tr_b16 v[174:175], v67 offset:41472
    v_mfma_f32_16x16x32_bf16 v[88:91], v[156:159], v[120:123], v[88:91]
    v_mfma_f32_16x16x32_bf16 v[92:95], v[156:159], v[124:127], v[92:95]
    v_mfma_f32_16x16x32_bf16 v[96:99], v[156:159], v[128:131], v[96:99]
    v_mfma_f32_16x16x32_bf16 v[100:103], v[156:159], v[132:135], v[100:103]
    v_mfma_f32_16x16x32_bf16 v[180:183], v[156:159], v[188:191], v[180:183]
    v_mfma_f32_16x16x32_bf16 v[104:107], v[160:163], v[120:123], v[104:107]
    v_mfma_f32_16x16x32_bf16 v[108:111], v[160:163], v[124:127], v[108:111]
    v_mfma_f32_16x16x32_bf16 v[112:115], v[160:163], v[128:131], v[112:115]
    v_mfma_f32_16x16x32_bf16 v[116:119], v[160:163], v[132:135], v[116:119]
    v_mfma_f32_16x16x32_bf16 v[184:187], v[160:163], v[188:191], v[184:187]
    s_cmp_lg_u32 s30, 7
    s_cbranch_scc1 F_POK1
    s_lshl_b32 s3, s28, 7
    s_add_u32 s3, s3, 13113344
    v_lshl_add_u32 v7, v3, 2, s3
    buffer_load_dword v8, v7, s[16:19], 0 offen
    s_waitcnt vmcnt(0)
    v_cmp_ne_u32 vcc, 0, v8
    s_nop 2
    s_cmp_eq_u64 vcc, -1
    s_cbranch_scc1 F_POK1
    s_mov_b32 s4, 0
F_PSP1:
    buffer_load_dword v8, v7, s[16:19], 0 offen sc0 sc1
    s_waitcnt vmcnt(0)
    v_cmp_ne_u32 vcc, 0, v8
    s_nop 2
    s_cmp_eq_u64 vcc, -1
    s_cbranch_scc1 F_POK1
    s_add_u32 s4, s4, 1
    s_cmp_ge_u32 s4, 60000
    s_cbranch_scc1 F_POK1
    s_sleep 4
    s_branch F_PSP1
F_POK1:
    s_waitcnt lgkmcnt(0)
    s_barrier
    v_mfma_f32_16x16x32_bf16 v[72:75], v[164:167], v[136:139], v[72:75]
    v_mfma_f32_16x16x32_bf16 v[76:79], v[164:167], v[140:143], v[76:79]
    v_mfma_f32_16x16x32_bf16 v[80:83], v[164:167], v[144:147], v[80:83]
    v_mfma_f32_16x16x32_bf16 v[84:87], v[164:167], v[148:151], v[84:87]
    v_mfma_f32_16x16x32_bf16 v[88:91], v[168:171], v[136:139], v[88:91]
    v_mfma_f32_16x16x32_bf16 v[92:95], v[168:171], v[140:143], v[92:95]
    v_mfma_f32_16x16x32_bf16 v[96:99], v[168:171], v[144:147], v[96:99]
    v_mfma_f32_16x16x32_bf16 v[100:103], v[168:171], v[148:151], v[100:103]
    v_mfma_f32_16x16x32_bf16 v[104:107], v[172:175], v[136:139], v[104:107]
    v_mfma_f32_16x16x32_bf16 v[108:111], v[172:175], v[140:143], v[108:111]
    v_mfma_f32_16x16x32_bf16 v[112:115], v[172:175], v[144:147], v[112:115]
    v_mfma_f32_16x16x32_bf16 v[116:119], v[172:175], v[148:151], v[116:119]
    s_cmp_eq_u32 s30, 7
    s_cbranch_scc1 F_NOP7X1
    s_add_u32 m0, s34, 122880
    s_add_u32 s39, s36, 0
    buffer_load_dwordx4 v12, s[8:11], s39 offen lds
    s_add_u32 m0, s34, 123904
    s_add_u32 s39, s36, 8192
    buffer_load_dwordx4 v12, s[8:11], s39 offen lds
    s_add_u32 m0, s34, 124928
    s_add_u32 s39, s36, 16384
    buffer_load_dwordx4 v12, s[8:11], s39 offen lds
    s_add_u32 m0, s34, 125952
    s_add_u32 s39, s36, 24576
    buffer_load_dwordx4 v12, s[8:11], s39 offen lds
    s_add_u32 m0, s35, 0
    s_add_u32 s39, s36, 32768
    buffer_load_dwordx4 v12, s[8:11], s39 offen lds
    s_add_u32 m0, s35, 1024
    s_add_u32 s39, s36, 40960
    buffer_load_dwordx4 v12, s[8:11], s39 offen lds
    s_add_u32 m0, s35, 2048
    s_add_u32 s39, s36, 1064960
    buffer_load_dwordx4 v12, s[8:11], s39 offen lds
    s_add_u32 m0, s35, 3072
    s_add_u32 s39, s36, 1073152
    buffer_load_dwordx4 v12, s[8:11], s39 offen lds
F_NOP7X1:
    v_lshrrev_b32 v7, 2, v3
    v_lshl_add_u32 v7, v4, 2, v7
    v_lshrrev_b32 v8, 1, v7
    v_and_b32 v8, 3, v8
    v_and_b32 v9, 3, v3
    v_lshlrev_b32 v9, 3, v9
    v_lshl_add_u32 v9, v7, 7, v9
    v_add_u32 v9, s34, v9
    v_xor_b32 v7, 0, v8
    v_lshl_add_u32 v192, v7, 5, v9
    v_xor_b32 v7, 1, v8
    v_lshl_add_u32 v193, v7, 5, v9
    v_xor_b32 v7, 2, v8
    v_lshl_add_u32 v194, v7, 5, v9
    v_xor_b32 v7, 3, v8
    v_lshl_add_u32 v195, v7, 5, v9
    s_cmp_lg_u32 s30, 7
    s_cbranch_scc1 F_NOZF1
    v_mov_b32 v7, 154624
    v_mov_b32 v8, 0
    v_mov_b32 v9, 0
    v_lshl_add_u32 v7, v2, 3, v7
    v_mov_b32 v120, 0
    v_mov_b32 v121, 0
    ds_write_b64 v7, v[120:121]
    s_waitcnt vmcnt(0)
F_NOZF1:
    s_waitcnt vmcnt(8)
    ds_read_b64_tr_b16 v[208:209], v192 offset:0
    ds_read_b64_tr_b16 v[212:213], v193 offset:0
    ds_read_b64_tr_b16 v[216:217], v194 offset:0
    ds_read_b64_tr_b16 v[220:221], v195 offset:0
    ds_read_b64_tr_b16 v[210:211], v192 offset:2048
    ds_read_b64_tr_b16 v[214:215], v193 offset:2048
    ds_read_b64_tr_b16 v[218:219], v194 offset:2048
    ds_read_b64_tr_b16 v[222:223], v195 offset:2048
    ds_read_b64_tr_b16 v[224:225], v192 offset:40960
    ds_read_b64_tr_b16 v[228:229], v193 offset:40960
    ds_read_b64_tr_b16 v[232:233], v194 offset:40960
    ds_read_b64_tr_b16 v[236:237], v195 offset:40960
    ds_read_b64_tr_b16 v[226:227], v192 offset:43008
    ds_read_b64_tr_b16 v[230:231], v193 offset:43008
    ds_read_b64_tr_b16 v[234:235], v194 offset:43008
    ds_read_b64_tr_b16 v[238:239], v195 offset:43008
    s_waitcnt lgkmcnt(8)
    v_add_u32 v7, 81920, v192
    v_add_u32 v8, 81920, v193
    v_add_u32 v9, 81920, v194
    v_add_u32 v196, 81920, v195
    ds_read_b64_tr_b16 v[240:241], v7 offset:0
    ds_read_b64_tr_b16 v[242:243], v7 offset:2048
    ds_read_b64_tr_b16 v[244:245], v8 offset:0
    ds_read_b64_tr_b16 v[246:247], v8 offset:2048
    ds_read_b64_tr_b16 v[248:249], v9 offset:0
    ds_read_b64_tr_b16 v[250:251], v9 offset:2048
    ds_read_b64_tr_b16 v[252:253], v196 offset:0
    ds_read_b64_tr_b16 v[254:255], v196 offset:2048
    s_waitcnt lgkmcnt(0)
    s_add_u32 s3, s32, 0
    s_and_b32 s3, s3, 3
    s_lshl_b32 s3, s3, 4
    s_lshl_b32 s4, s31, 6
    s_add_u32 s3, s3, s4
    s_lshl_b32 s4, s28, 7
    s_add_u32 s3, s3, s4
    s_lshl_b32 s3, s3, 4
    s_add_u32 s3, s3, 13041664
    v_lshl_add_u32 v9, v3, 4, s3
    buffer_load_dwordx4 v[120:123], v9, s[16:19], 0 offen
    s_add_u32 s3, s32, 1
    s_and_b32 s3, s3, 3
    s_lshl_b32 s3, s3, 4
    s_lshl_b32 s4, s31, 6
    s_add_u32 s3, s3, s4
    s_lshl_b32 s4, s28, 7
    s_add_u32 s3, s3, s4
    s_lshl_b32 s3, s3, 4
    s_add_u32 s3, s3, 13041664
    v_lshl_add_u32 v9, v3, 4, s3
    buffer_load_dwordx4 v[124:127], v9, s[16:19], 0 offen
    s_add_u32 s3, s32, 2
    s_and_b32 s3, s3, 3
    s_lshl_b32 s3, s3, 4
    s_lshl_b32 s4, s31, 6
    s_add_u32 s3, s3, s4
    s_lshl_b32 s4, s28, 7
    s_add_u32 s3, s3, s4
    s_lshl_b32 s3, s3, 4
    s_add_u32 s3, s3, 13041664
    v_lshl_add_u32 v9, v3, 4, s3
    buffer_load_dwordx4 v[128:131], v9, s[16:19], 0 offen
    s_add_u32 s3, s32, 3
    s_and_b32 s3, s3, 3
    s_lshl_b32 s3, s3, 4
    s_lshl_b32 s4, s31, 6
    s_add_u32 s3, s3, s4
    s_lshl_b32 s4, s28, 7
    s_add_u32 s3, s3, s4
    s_lshl_b32 s3, s3, 4
    s_add_u32 s3, s3, 13041664
    v_lshl_add_u32 v9, v3, 4, s3
    buffer_load_dwordx4 v[132:135], v9, s[16:19], 0 offen
    s_mul_i32 s3, s31, 768
    s_mul_i32 s4, s32, 192
    s_add_u32 s3, s3, s4
    s_add_u32 s3, s3, 152576
    v_lshl_add_u32 v9, v4, 4, s3
    v_cmp_eq_u32 vcc, 0, v3
    s_nop 2
    s_and_saveexec_b64 s[6:7], vcc
    ds_write_b128 v9, v[176:179]
    ds_write_b128 v9, v[180:183] offset:64
    ds_write_b128 v9, v[184:187] offset:128
    s_mov_b64 exec, s[6:7]
    s_lshl_b32 s3, s28, 1
    s_add_u32 s3, s3, s31
    s_lshl_b32 s100, s3, 2
    s_waitcnt lgkmcnt(0)
    s_barrier
    s_mul_i32 s4, s32, 192
    s_xor_b32 s3, s31, 1
    s_mul_i32 s3, s3, 768
    s_add_u32 s4, s4, s3
    s_add_u32 s4, s4, 152576
    v_lshl_add_u32 v9, v4, 4, s4
    ds_read_b128 v[136:139], v9 offset:0
    ds_read_b128 v[140:143], v9 offset:64
    ds_read_b128 v[144:147], v9 offset:128
    v_lshlrev_b32 v148, 16, v14
    v_and_b32 v149, 0xffff0000, v14
    v_lshlrev_b32 v150, 16, v15
    v_and_b32 v151, 0xffff0000, v15
    v_lshlrev_b32 v152, 16, v16
    v_and_b32 v153, 0xffff0000, v16
    v_lshlrev_b32 v154, 16, v17
    v_and_b32 v155, 0xffff0000, v17
    v_lshlrev_b32 v156, 16, v18
    v_and_b32 v157, 0xffff0000, v18
    v_lshlrev_b32 v158, 16, v19
    v_and_b32 v159, 0xffff0000, v19
    s_mov_b32 s40, 0xc0135761
    s_mov_b32 s41, 0xc0135761
    s_mov_b32 s42, 0xbdd2d3e8
    s_mov_b32 s43, 0xbdd2d3e8
    s_mov_b32 s44, 1.0
    s_mov_b32 s45, 1.0
    v_mov_b32 v168, s40
    v_mov_b32 v169, s41
    s_waitcnt vmcnt(0) lgkmcnt(0)
    v_pk_add_f32 v[176:177], v[176:177], v[136:137]
    v_pk_add_f32 v[178:179], v[178:179], v[138:139]
    v_pk_add_f32 v[180:181], v[180:181], v[140:141]
    v_pk_add_f32 v[182:183], v[182:183], v[142:143]
    v_pk_add_f32 v[184:185], v[184:185], v[144:145]
    v_pk_add_f32 v[186:187], v[186:187], v[146:147]
    v_sub_f32 v122, 1.0, v122
    v_sub_f32 v126, 1.0, v126
    v_sub_f32 v130, 1.0, v130
    v_sub_f32 v134, 1.0, v134
    v_max_f32 v122, 0x0da24260, v122
    v_max_f32 v126, 0x0da24260, v126
    v_max_f32 v130, 0x0da24260, v130
    v_max_f32 v134, 0x0da24260, v134
    v_rcp_f32 v122, v122
    v_rcp_f32 v126, v126
    v_rcp_f32 v130, v130
    v_rcp_f32 v134, v134
    s_add_u32 s3, s32, 0
    s_and_b32 s3, s3, 3
    s_lshl_b32 s4, s28, 3
    s_add_u32 s3, s3, s4
    s_lshl_b32 s4, s31, 2
    s_add_u32 s3, s3, s4
    s_mul_i32 s3, s3, 29
    s_add_u32 s3, s3, s68
    s_lshl_b32 s4, s3, 10
    v_lshl_add_u32 v160, v2, 4, s4
    s_lshl_b32 s4, s3, 9
    s_add_u32 s4, s4, 4194304
    v_lshl_add_u32 v164, v2, 3, s4
    s_add_u32 s3, s32, 1
    s_and_b32 s3, s3, 3
    s_lshl_b32 s4, s28, 3
    s_add_u32 s3, s3, s4
    s_lshl_b32 s4, s31, 2
    s_add_u32 s3, s3, s4
    s_mul_i32 s3, s3, 29
    s_add_u32 s3, s3, s68
    s_lshl_b32 s4, s3, 10
    v_lshl_add_u32 v161, v2, 4, s4
    s_lshl_b32 s4, s3, 9
    s_add_u32 s4, s4, 4194304
    v_lshl_add_u32 v165, v2, 3, s4
    s_add_u32 s3, s32, 2
    s_and_b32 s3, s3, 3
    s_lshl_b32 s4, s28, 3
    s_add_u32 s3, s3, s4
    s_lshl_b32 s4, s31, 2
    s_add_u32 s3, s3, s4
    s_mul_i32 s3, s3, 29
    s_add_u32 s3, s3, s68
    s_lshl_b32 s4, s3, 10
    v_lshl_add_u32 v162, v2, 4, s4
    s_lshl_b32 s4, s3, 9
    s_add_u32 s4, s4, 4194304
    v_lshl_add_u32 v166, v2, 3, s4
    s_add_u32 s3, s32, 3
    s_and_b32 s3, s3, 3
    s_lshl_b32 s4, s28, 3
    s_add_u32 s3, s3, s4
    s_lshl_b32 s4, s31, 2
    s_add_u32 s3, s3, s4
    s_mul_i32 s3, s3, 29
    s_add_u32 s3, s3, s68
    s_lshl_b32 s4, s3, 10
    v_lshl_add_u32 v163, v2, 4, s4
    s_lshl_b32 s4, s3, 9
    s_add_u32 s4, s4, 4194304
    v_lshl_add_u32 v167, v2, 3, s4
    s_cmp_gt_u32 s68, 28
    s_cbranch_scc1 F_HSKIP
    v_pk_fma_f32 v[136:137], v[176:177], v[120:121], v[148:149] op_sel:[0,1,0] op_sel_hi:[1,1,1] neg_lo:[0,1,0] neg_hi:[0,1,0]
    v_pk_fma_f32 v[140:141], v[178:179], v[120:121], v[150:151] op_sel:[0,1,0] op_sel_hi:[1,1,1] neg_lo:[0,1,0] neg_hi:[0,1,0]
    v_pk_fma_f32 v[144:145], v[180:181], v[120:121], v[152:153] op_sel:[0,1,0] op_sel_hi:[1,1,1] neg_lo:[0,1,0] neg_hi:[0,1,0]
    v_pk_fma_f32 v[72:73], v[72:73], v[120:121], v[136:137] op_sel_hi:[1,0,1]
    v_pk_fma_f32 v[74:75], v[74:75], v[120:121], v[140:141] op_sel_hi:[1,0,1]
    v_pk_fma_f32 v[88:89], v[88:89], v[120:121], v[144:145] op_sel_hi:[1,0,1]
    v_pk_mul_f32 v[136:137], v[72:73], v[72:73]
    v_pk_mul_f32 v[140:141], v[74:75], v[74:75]
    v_pk_mul_f32 v[144:145], v[88:89], v[88:89]
    v_pk_fma_f32 v[136:137], v[136:137], s[42:43], v[168:169]
    v_pk_fma_f32 v[140:141], v[140:141], s[42:43], v[168:169]
    v_pk_fma_f32 v[144:145], v[144:145], s[42:43], v[168:169]
    s_add_u32 m0, s34, 0
    s_add_u32 s39, s36, 344064
    buffer_load_dwordx4 v12, s[8:11], s39 offen lds
    v_pk_mul_f32 v[136:137], v[136:137], v[72:73]
    v_pk_mul_f32 v[140:141], v[140:141], v[74:75]
    v_pk_mul_f32 v[144:145], v[144:145], v[88:89]
    v_exp_f32 v136, v136
    v_exp_f32 v140, v140
    v_exp_f32 v144, v144
    v_exp_f32 v137, v137
    v_exp_f32 v141, v141
    v_exp_f32 v145, v145
    v_pk_fma_f32 v[136:137], v[136:137], v[122:123], v[122:123] op_sel_hi:[1,0,0]
    v_pk_fma_f32 v[140:141], v[140:141], v[122:123], v[122:123] op_sel_hi:[1,0,0]
    v_pk_fma_f32 v[144:145], v[144:145], v[122:123], v[122:123] op_sel_hi:[1,0,0]
    s_add_u32 m0, s34, 1024
    s_add_u32 s39, s36, 352256
    buffer_load_dwordx4 v12, s[8:11], s39 offen lds
    v_rcp_f32 v136, v136
    v_rcp_f32 v140, v140
    v_rcp_f32 v144, v144
    v_rcp_f32 v137, v137
    v_rcp_f32 v141, v141
    v_rcp_f32 v145, v145
    v_pk_mul_f32 v[72:73], v[72:73], v[136:137]
    v_pk_mul_f32 v[74:75], v[74:75], v[140:141]
    v_pk_mul_f32 v[88:89], v[88:89], v[144:145]
    v_cvt_pk_bf16_f32 v40, v72, v73
    v_cvt_pk_bf16_f32 v41, v74, v75
    v_cvt_pk_bf16_f32 v42, v88, v89
    v_pk_fma_f32 v[136:137], v[182:183], v[120:121], v[154:155] op_sel:[0,1,0] op_sel_hi:[1,1,1] neg_lo:[0,1,0] neg_hi:[0,1,0]
    v_pk_fma_f32 v[140:141], v[184:185], v[120:121], v[156:157] op_sel:[0,1,0] op_sel_hi:[1,1,1] neg_lo:[0,1,0] neg_hi:[0,1,0]
    v_pk_fma_f32 v[144:145], v[186:187], v[120:121], v[158:159] op_sel:[0,1,0] op_sel_hi:[1,1,1] neg_lo:[0,1,0] neg_hi:[0,1,0]
    v_pk_fma_f32 v[90:91], v[90:91], v[120:121], v[136:137] op_sel_hi:[1,0,1]
    v_pk_fma_f32 v[104:105], v[104:105], v[120:121], v[140:141] op_sel_hi:[1,0,1]
    v_pk_fma_f32 v[106:107], v[106:107], v[120:121], v[144:145] op_sel_hi:[1,0,1]
    v_pk_mul_f32 v[136:137], v[90:91], v[90:91]
    v_pk_mul_f32 v[140:141], v[104:105], v[104:105]
    v_pk_mul_f32 v[144:145], v[106:107], v[106:107]
    v_pk_fma_f32 v[136:137], v[136:137], s[42:43], v[168:169]
    v_pk_fma_f32 v[140:141], v[140:141], s[42:43], v[168:169]
    v_pk_fma_f32 v[144:145], v[144:145], s[42:43], v[168:169]
    v_pk_mul_f32 v[136:137], v[136:137], v[90:91]
    v_pk_mul_f32 v[140:141], v[140:141], v[104:105]
    v_pk_mul_f32 v[144:145], v[144:145], v[106:107]
    v_exp_f32 v136, v136
    v_exp_f32 v140, v140
    v_exp_f32 v144, v144
    s_add_u32 m0, s34, 2048
    s_add_u32 s39, s36, 360448
    buffer_load_dwordx4 v12, s[8:11], s39 offen lds
    v_exp_f32 v137, v137
    v_exp_f32 v141, v141
    v_exp_f32 v145, v145
    v_pk_fma_f32 v[136:137], v[136:137], v[122:123], v[122:123] op_sel_hi:[1,0,0]
    v_pk_fma_f32 v[140:141], v[140:141], v[122:123], v[122:123] op_sel_hi:[1,0,0]
    v_pk_fma_f32 v[144:145], v[144:145], v[122:123], v[122:123] op_sel_hi:[1,0,0]
    v_rcp_f32 v136, v136
    v_rcp_f32 v140, v140
    v_rcp_f32 v144, v144
    v_rcp_f32 v137, v137
    v_rcp_f32 v141, v141
    v_rcp_f32 v145, v145
    v_pk_mul_f32 v[90:91], v[90:91], v[136:137]
    v_pk_mul_f32 v[104:105], v[104:105], v[140:141]
    v_pk_mul_f32 v[106:107], v[106:107], v[144:145]
    v_cvt_pk_bf16_f32 v43, v90, v91
    v_cvt_pk_bf16_f32 v44, v104, v105
    v_cvt_pk_bf16_f32 v45, v106, v107
    buffer_store_dwordx4 v[40:43], v160, s[16:19], 0 offen sc1
    s_cmp_eq_u32 s68, 28
    s_cbranch_scc1 F_SKIP16_0
    buffer_store_dwordx2 v[44:45], v164, s[16:19], 0 offen sc1
F_SKIP16_0:
    v_pk_fma_f32 v[136:137], v[176:177], v[124:125], v[148:149] op_sel:[0,1,0] op_sel_hi:[1,1,1] neg_lo:[0,1,0] neg_hi:[0,1,0]
    v_pk_fma_f32 v[140:141], v[178:179], v[124:125], v[150:151] op_sel:[0,1,0] op_sel_hi:[1,1,1] neg_lo:[0,1,0] neg_hi:[0,1,0]
    v_pk_fma_f32 v[144:145], v[180:181], v[124:125], v[152:153] op_sel:[0,1,0] op_sel_hi:[1,1,1] neg_lo:[0,1,0] neg_hi:[0,1,0]
    v_pk_fma_f32 v[76:77], v[76:77], v[124:125], v[136:137] op_sel_hi:[1,0,1]
    v_pk_fma_f32 v[78:79], v[78:79], v[124:125], v[140:141] op_sel_hi:[1,0,1]
    v_pk_fma_f32 v[92:93], v[92:93], v[124:125], v[144:145] op_sel_hi:[1,0,1]
    v_pk_mul_f32 v[136:137], v[76:77], v[76:77]
    v_pk_mul_f32 v[140:141], v[78:79], v[78:79]
    v_pk_mul_f32 v[144:145], v[92:93], v[92:93]
    v_pk_fma_f32 v[136:137], v[136:137], s[42:43], v[168:169]
    v_pk_fma_f32 v[140:141], v[140:141], s[42:43], v[168:169]
    v_pk_fma_f32 v[144:145], v[144:145], s[42:43], v[168:169]
    s_add_u32 m0, s34, 3072
    s_add_u32 s39, s36, 368640
    buffer_load_dwordx4 v12, s[8:11], s39 offen lds
    v_pk_mul_f32 v[136:137], v[136:137], v[76:77]
    v_pk_mul_f32 v[140:141], v[140:141], v[78:79]
    v_pk_mul_f32 v[144:145], v[144:145], v[92:93]
    v_exp_f32 v136, v136
    v_exp_f32 v140, v140
    v_exp_f32 v144, v144
    v_exp_f32 v137, v137
    v_exp_f32 v141, v141
    v_exp_f32 v145, v145
    v_pk_fma_f32 v[136:137], v[136:137], v[126:127], v[126:127] op_sel_hi:[1,0,0]
    v_pk_fma_f32 v[140:141], v[140:141], v[126:127], v[126:127] op_sel_hi:[1,0,0]
    v_pk_fma_f32 v[144:145], v[144:145], v[126:127], v[126:127] op_sel_hi:[1,0,0]
    s_add_u32 m0, s34, 40960
    s_add_u32 s39, s36, 376832
    buffer_load_dwordx4 v12, s[8:11], s39 offen lds
    v_rcp_f32 v136, v136
    v_rcp_f32 v140, v140
    v_rcp_f32 v144, v144
    v_rcp_f32 v137, v137
    v_rcp_f32 v141, v141
    v_rcp_f32 v145, v145
    v_pk_mul_f32 v[76:77], v[76:77], v[136:137]
    v_pk_mul_f32 v[78:79], v[78:79], v[140:141]
    v_pk_mul_f32 v[92:93], v[92:93], v[144:145]
    v_cvt_pk_bf16_f32 v46, v76, v77
    v_cvt_pk_bf16_f32 v47, v78, v79
    v_cvt_pk_bf16_f32 v48, v92, v93
    v_pk_fma_f32 v[136:137], v[182:183], v[124:125], v[154:155] op_sel:[0,1,0] op_sel_hi:[1,1,1] neg_lo:[0,1,0] neg_hi:[0,1,0]
    v_pk_fma_f32 v[140:141], v[184:185], v[124:125], v[156:157] op_sel:[0,1,0] op_sel_hi:[1,1,1] neg_lo:[0,1,0] neg_hi:[0,1,0]
    v_pk_fma_f32 v[144:145], v[186:187], v[124:125], v[158:159] op_sel:[0,1,0] op_sel_hi:[1,1,1] neg_lo:[0,1,0] neg_hi:[0,1,0]
    v_pk_fma_f32 v[94:95], v[94:95], v[124:125], v[136:137] op_sel_hi:[1,0,1]
    v_pk_fma_f32 v[108:109], v[108:109], v[124:125], v[140:141] op_sel_hi:[1,0,1]
    v_pk_fma_f32 v[110:111], v[110:111], v[124:125], v[144:145] op_sel_hi:[1,0,1]
    v_pk_mul_f32 v[136:137], v[94:95], v[94:95]
    v_pk_mul_f32 v[140:141], v[108:109], v[108:109]
    v_pk_mul_f32 v[144:145], v[110:111], v[110:111]
    v_pk_fma_f32 v[136:137], v[136:137], s[42:43], v[168:169]
    v_pk_fma_f32 v[140:141], v[140:141], s[42:43], v[168:169]
    v_pk_fma_f32 v[144:145], v[144:145], s[42:43], v[168:169]
    v_pk_mul_f32 v[136:137], v[136:137], v[94:95]
    v_pk_mul_f32 v[140:141], v[140:141], v[108:109]
    v_pk_mul_f32 v[144:145], v[144:145], v[110:111]
    v_exp_f32 v136, v136
    v_exp_f32 v140, v140
    v_exp_f32 v144, v144
    s_add_u32 m0, s34, 41984
    s_add_u32 s39, s36, 385024
    buffer_load_dwordx4 v12, s[8:11], s39 offen lds
    v_exp_f32 v137, v137
    v_exp_f32 v141, v141
    v_exp_f32 v145, v145
    v_pk_fma_f32 v[136:137], v[136:137], v[126:127], v[126:127] op_sel_hi:[1,0,0]
    v_pk_fma_f32 v[140:141], v[140:141], v[126:127], v[126:127] op_sel_hi:[1,0,0]
    v_pk_fma_f32 v[144:145], v[144:145], v[126:127], v[126:127] op_sel_hi:[1,0,0]
    v_rcp_f32 v136, v136
    v_rcp_f32 v140, v140
    v_rcp_f32 v144, v144
    v_rcp_f32 v137, v137
    v_rcp_f32 v141, v141
    v_rcp_f32 v145, v145
    v_pk_mul_f32 v[94:95], v[94:95], v[136:137]
    v_pk_mul_f32 v[108:109], v[108:109], v[140:141]
    v_pk_mul_f32 v[110:111], v[110:111], v[144:145]
    v_cvt_pk_bf16_f32 v49, v94, v95
    v_cvt_pk_bf16_f32 v50, v108, v109
    v_cvt_pk_bf16_f32 v51, v110, v111
    buffer_store_dwordx4 v[46:49], v161, s[16:19], 0 offen sc1
    s_cmp_eq_u32 s68, 28
    s_cbranch_scc1 F_SKIP16_1
    buffer_store_dwordx2 v[50:51], v165, s[16:19], 0 offen sc1
F_SKIP16_1:
    v_pk_fma_f32 v[136:137], v[176:177], v[128:129], v[148:149] op_sel:[0,1,0] op_sel_hi:[1,1,1] neg_lo:[0,1,0] neg_hi:[0,1,0]
    v_pk_fma_f32 v[140:141], v[178:179], v[128:129], v[150:151] op_sel:[0,1,0] op_sel_hi:[1,1,1] neg_lo:[0,1,0] neg_hi:[0,1,0]
    v_pk_fma_f32 v[144:145], v[180:181], v[128:129], v[152:153] op_sel:[0,1,0] op_sel_hi:[1,1,1] neg_lo:[0,1,0] neg_hi:[0,1,0]
    v_pk_fma_f32 v[80:81], v[80:81], v[128:129], v[136:137] op_sel_hi:[1,0,1]
    v_pk_fma_f32 v[82:83], v[82:83], v[128:129], v[140:141] op_sel_hi:[1,0,1]
    v_pk_fma_f32 v[96:97], v[96:97], v[128:129], v[144:145] op_sel_hi:[1,0,1]
    v_pk_mul_f32 v[136:137], v[80:81], v[80:81]
    v_pk_mul_f32 v[140:141], v[82:83], v[82:83]
    v_pk_mul_f32 v[144:145], v[96:97], v[96:97]
    v_pk_fma_f32 v[136:137], v[136:137], s[42:43], v[168:169]
    v_pk_fma_f32 v[140:141], v[140:141], s[42:43], v[168:169]
    v_pk_fma_f32 v[144:145], v[144:145], s[42:43], v[168:169]
    s_add_u32 m0, s34, 43008
    s_add_u32 s39, s36, 720896
    buffer_load_dwordx4 v12, s[8:11], s39 offen lds
    v_pk_mul_f32 v[136:137], v[136:137], v[80:81]
    v_pk_mul_f32 v[140:141], v[140:141], v[82:83]
    v_pk_mul_f32 v[144:145], v[144:145], v[96:97]
    v_exp_f32 v136, v136
    v_exp_f32 v140, v140
    v_exp_f32 v144, v144
    v_exp_f32 v137, v137
    v_exp_f32 v141, v141
    v_exp_f32 v145, v145
    v_pk_fma_f32 v[136:137], v[136:137], v[130:131], v[130:131] op_sel_hi:[1,0,0]
    v_pk_fma_f32 v[140:141], v[140:141], v[130:131], v[130:131] op_sel_hi:[1,0,0]
    v_pk_fma_f32 v[144:145], v[144:145], v[130:131], v[130:131] op_sel_hi:[1,0,0]
    s_add_u32 m0, s34, 44032
    s_add_u32 s39, s36, 729088
    buffer_load_dwordx4 v12, s[8:11], s39 offen lds
    v_rcp_f32 v136, v136
    v_rcp_f32 v140, v140
    v_rcp_f32 v144, v144
    v_rcp_f32 v137, v137
    v_rcp_f32 v141, v141
    v_rcp_f32 v145, v145
    v_pk_mul_f32 v[80:81], v[80:81], v[136:137]
    v_pk_mul_f32 v[82:83], v[82:83], v[140:141]
    v_pk_mul_f32 v[96:97], v[96:97], v[144:145]
    v_cvt_pk_bf16_f32 v52, v80, v81
    v_cvt_pk_bf16_f32 v53, v82, v83
    v_cvt_pk_bf16_f32 v54, v96, v97
    v_pk_fma_f32 v[136:137], v[182:183], v[128:129], v[154:155] op_sel:[0,1,0] op_sel_hi:[1,1,1] neg_lo:[0,1,0] neg_hi:[0,1,0]
    v_pk_fma_f32 v[140:141], v[184:185], v[128:129], v[156:157] op_sel:[0,1,0] op_sel_hi:[1,1,1] neg_lo:[0,1,0] neg_hi:[0,1,0]
    v_pk_fma_f32 v[144:145], v[186:187], v[128:129], v[158:159] op_sel:[0,1,0] op_sel_hi:[1,1,1] neg_lo:[0,1,0] neg_hi:[0,1,0]
    v_pk_fma_f32 v[98:99], v[98:99], v[128:129], v[136:137] op_sel_hi:[1,0,1]
    v_pk_fma_f32 v[112:113], v[112:113], v[128:129], v[140:141] op_sel_hi:[1,0,1]
    v_pk_fma_f32 v[114:115], v[114:115], v[128:129], v[144:145] op_sel_hi:[1,0,1]
    v_pk_mul_f32 v[136:137], v[98:99], v[98:99]
    v_pk_mul_f32 v[140:141], v[112:113], v[112:113]
    v_pk_mul_f32 v[144:145], v[114:115], v[114:115]
    v_pk_fma_f32 v[136:137], v[136:137], s[42:43], v[168:169]
    v_pk_fma_f32 v[140:141], v[140:141], s[42:43], v[168:169]
    v_pk_fma_f32 v[144:145], v[144:145], s[42:43], v[168:169]
    v_pk_mul_f32 v[136:137], v[136:137], v[98:99]
    v_pk_mul_f32 v[140:141], v[140:141], v[112:113]
    v_pk_mul_f32 v[144:145], v[144:145], v[114:115]
    v_exp_f32 v136, v136
    v_exp_f32 v140, v140
    v_exp_f32 v144, v144
    s_add_u32 m0, s34, 81920
    s_add_u32 s39, s36, 688128
    buffer_load_dwordx4 v12, s[8:11], s39 offen lds
    v_exp_f32 v137, v137
    v_exp_f32 v141, v141
    v_exp_f32 v145, v145
    v_pk_fma_f32 v[136:137], v[136:137], v[130:131], v[130:131] op_sel_hi:[1,0,0]
    v_pk_fma_f32 v[140:141], v[140:141], v[130:131], v[130:131] op_sel_hi:[1,0,0]
    v_pk_fma_f32 v[144:145], v[144:145], v[130:131], v[130:131] op_sel_hi:[1,0,0]
    v_rcp_f32 v136, v136
    v_rcp_f32 v140, v140
    v_rcp_f32 v144, v144
    v_rcp_f32 v137, v137
    v_rcp_f32 v141, v141
    v_rcp_f32 v145, v145
    v_pk_mul_f32 v[98:99], v[98:99], v[136:137]
    v_pk_mul_f32 v[112:113], v[112:113], v[140:141]
    v_pk_mul_f32 v[114:115], v[114:115], v[144:145]
    v_cvt_pk_bf16_f32 v55, v98, v99
    v_cvt_pk_bf16_f32 v56, v112, v113
    v_cvt_pk_bf16_f32 v57, v114, v115
    buffer_store_dwordx4 v[52:55], v162, s[16:19], 0 offen sc1
    s_cmp_eq_u32 s68, 28
    s_cbranch_scc1 F_SKIP16_2
    buffer_store_dwordx2 v[56:57], v166, s[16:19], 0 offen sc1
F_SKIP16_2:
    v_pk_fma_f32 v[136:137], v[176:177], v[132:133], v[148:149] op_sel:[0,1,0] op_sel_hi:[1,1,1] neg_lo:[0,1,0] neg_hi:[0,1,0]
    v_pk_fma_f32 v[140:141], v[178:179], v[132:133], v[150:151] op_sel:[0,1,0] op_sel_hi:[1,1,1] neg_lo:[0,1,0] neg_hi:[0,1,0]
    v_pk_fma_f32 v[144:145], v[180:181], v[132:133], v[152:153] op_sel:[0,1,0] op_sel_hi:[1,1,1] neg_lo:[0,1,0] neg_hi:[0,1,0]
    v_pk_fma_f32 v[84:85], v[84:85], v[132:133], v[136:137] op_sel_hi:[1,0,1]
    v_pk_fma_f32 v[86:87], v[86:87], v[132:133], v[140:141] op_sel_hi:[1,0,1]
    v_pk_fma_f32 v[100:101], v[100:101], v[132:133], v[144:145] op_sel_hi:[1,0,1]
    v_pk_mul_f32 v[136:137], v[84:85], v[84:85]
    v_pk_mul_f32 v[140:141], v[86:87], v[86:87]
    v_pk_mul_f32 v[144:145], v[100:101], v[100:101]
    v_pk_fma_f32 v[136:137], v[136:137], s[42:43], v[168:169]
    v_pk_fma_f32 v[140:141], v[140:141], s[42:43], v[168:169]
    v_pk_fma_f32 v[144:145], v[144:145], s[42:43], v[168:169]
    s_add_u32 m0, s34, 82944
    s_add_u32 s39, s36, 696320
    buffer_load_dwordx4 v12, s[8:11], s39 offen lds
    v_pk_mul_f32 v[136:137], v[136:137], v[84:85]
    v_pk_mul_f32 v[140:141], v[140:141], v[86:87]
    v_pk_mul_f32 v[144:145], v[144:145], v[100:101]
    v_exp_f32 v136, v136
    v_exp_f32 v140, v140
    v_exp_f32 v144, v144
    v_exp_f32 v137, v137
    v_exp_f32 v141, v141
    v_exp_f32 v145, v145
    v_pk_fma_f32 v[136:137], v[136:137], v[134:135], v[134:135] op_sel_hi:[1,0,0]
    v_pk_fma_f32 v[140:141], v[140:141], v[134:135], v[134:135] op_sel_hi:[1,0,0]
    v_pk_fma_f32 v[144:145], v[144:145], v[134:135], v[134:135] op_sel_hi:[1,0,0]
    s_add_u32 m0, s34, 83968
    s_add_u32 s39, s36, 704512
    buffer_load_dwordx4 v12, s[8:11], s39 offen lds
    v_rcp_f32 v136, v136
    v_rcp_f32 v140, v140
    v_rcp_f32 v144, v144
    v_rcp_f32 v137, v137
    v_rcp_f32 v141, v141
    v_rcp_f32 v145, v145
    v_pk_mul_f32 v[84:85], v[84:85], v[136:137]
    v_pk_mul_f32 v[86:87], v[86:87], v[140:141]
    v_pk_mul_f32 v[100:101], v[100:101], v[144:145]
    v_cvt_pk_bf16_f32 v58, v84, v85
    v_cvt_pk_bf16_f32 v59, v86, v87
    v_cvt_pk_bf16_f32 v60, v100, v101
    v_pk_fma_f32 v[136:137], v[182:183], v[132:133], v[154:155] op_sel:[0,1,0] op_sel_hi:[1,1,1] neg_lo:[0,1,0] neg_hi:[0,1,0]
    v_pk_fma_f32 v[140:141], v[184:185], v[132:133], v[156:157] op_sel:[0,1,0] op_sel_hi:[1,1,1] neg_lo:[0,1,0] neg_hi:[0,1,0]
    v_pk_fma_f32 v[144:145], v[186:187], v[132:133], v[158:159] op_sel:[0,1,0] op_sel_hi:[1,1,1] neg_lo:[0,1,0] neg_hi:[0,1,0]
    v_pk_fma_f32 v[102:103], v[102:103], v[132:133], v[136:137] op_sel_hi:[1,0,1]
    v_pk_fma_f32 v[116:117], v[116:117], v[132:133], v[140:141] op_sel_hi:[1,0,1]
    v_pk_fma_f32 v[118:119], v[118:119], v[132:133], v[144:145] op_sel_hi:[1,0,1]
    v_pk_mul_f32 v[136:137], v[102:103], v[102:103]
    v_pk_mul_f32 v[140:141], v[116:117], v[116:117]
    v_pk_mul_f32 v[144:145], v[118:119], v[118:119]
    v_pk_fma_f32 v[136:137], v[136:137], s[42:43], v[168:169]
    v_pk_fma_f32 v[140:141], v[140:141], s[42:43], v[168:169]
    v_pk_fma_f32 v[144:145], v[144:145], s[42:43], v[168:169]
    v_pk_mul_f32 v[136:137], v[136:137], v[102:103]
    v_pk_mul_f32 v[140:141], v[140:141], v[116:117]
    v_pk_mul_f32 v[144:145], v[144:145], v[118:119]
    v_exp_f32 v136, v136
    v_exp_f32 v140, v140
    v_exp_f32 v144, v144
    s_add_u32 m0, s34, 84992
    s_add_u32 s39, s36, 712704
    buffer_load_dwordx4 v12, s[8:11], s39 offen lds
    v_exp_f32 v137, v137
    v_exp_f32 v141, v141
    v_exp_f32 v145, v145
    v_pk_fma_f32 v[136:137], v[136:137], v[134:135], v[134:135] op_sel_hi:[1,0,0]
    v_pk_fma_f32 v[140:141], v[140:141], v[134:135], v[134:135] op_sel_hi:[1,0,0]
    v_pk_fma_f32 v[144:145], v[144:145], v[134:135], v[134:135] op_sel_hi:[1,0,0]
    v_rcp_f32 v136, v136
    v_rcp_f32 v140, v140
    v_rcp_f32 v144, v144
    v_rcp_f32 v137, v137
    v_rcp_f32 v141, v141
    v_rcp_f32 v145, v145
    v_pk_mul_f32 v[102:103], v[102:103], v[136:137]
    v_pk_mul_f32 v[116:117], v[116:117], v[140:141]
    v_pk_mul_f32 v[118:119], v[118:119], v[144:145]
    v_cvt_pk_bf16_f32 v61, v102, v103
    v_cvt_pk_bf16_f32 v62, v116, v117
    v_cvt_pk_bf16_f32 v63, v118, v119
    buffer_store_dwordx4 v[58:61], v163, s[16:19], 0 offen sc1
    s_cmp_eq_u32 s68, 28
    s_cbranch_scc1 F_SKIP16_3
    buffer_store_dwordx2 v[62:63], v167, s[16:19], 0 offen sc1
F_SKIP16_3:
    s_branch F_HDONE
F_HSKIP:
    s_add_u32 m0, s34, 0
    s_add_u32 s39, s36, 344064
    buffer_load_dwordx4 v12, s[8:11], s39 offen lds
    s_add_u32 m0, s34, 1024
    s_add_u32 s39, s36, 352256
    buffer_load_dwordx4 v12, s[8:11], s39 offen lds
    s_add_u32 m0, s34, 2048
    s_add_u32 s39, s36, 360448
    buffer_load_dwordx4 v12, s[8:11], s39 offen lds
    s_add_u32 m0, s34, 3072
    s_add_u32 s39, s36, 368640
    buffer_load_dwordx4 v12, s[8:11], s39 offen lds
    s_add_u32 m0, s34, 40960
    s_add_u32 s39, s36, 376832
    buffer_load_dwordx4 v12, s[8:11], s39 offen lds
    s_add_u32 m0, s34, 41984
    s_add_u32 s39, s36, 385024
    buffer_load_dwordx4 v12, s[8:11], s39 offen lds
    s_add_u32 m0, s34, 43008
    s_add_u32 s39, s36, 720896
    buffer_load_dwordx4 v12, s[8:11], s39 offen lds
    s_add_u32 m0, s34, 44032
    s_add_u32 s39, s36, 729088
    buffer_load_dwordx4 v12, s[8:11], s39 offen lds
    s_add_u32 m0, s34, 81920
    s_add_u32 s39, s36, 688128
    buffer_load_dwordx4 v12, s[8:11], s39 offen lds
    s_add_u32 m0, s34, 82944
    s_add_u32 s39, s36, 696320
    buffer_load_dwordx4 v12, s[8:11], s39 offen lds
    s_add_u32 m0, s34, 83968
    s_add_u32 s39, s36, 704512
    buffer_load_dwordx4 v12, s[8:11], s39 offen lds
    s_add_u32 m0, s34, 84992
    s_add_u32 s39, s36, 712704
    buffer_load_dwordx4 v12, s[8:11], s39 offen lds
F_HDONE:
    s_waitcnt vmcnt(0)
    s_lshl_b32 s5, s31, 2
    s_add_u32 s5, s5, 154644
    v_mov_b32 v7, s5
    v_mov_b32 v8, 1
    s_mov_b64 s[6:7], exec
    s_mov_b64 exec, 1
    ds_add_rtn_u32 v8, v7, v8
    s_waitcnt lgkmcnt(0)
    v_readfirstlane_b32 s4, v8
    s_nop 2
    s_cmp_lg_u32 s4, 3
    s_cbranch_scc1 F_SIG1
    s_lshl_b32 s3, s100, 5
    s_lshl_b32 s4, s29, 2
    s_add_u32 s3, s3, s4
    s_add_u32 s3, s3, 13107200
    v_mov_b32 v7, s3
    v_mov_b32 v8, 1
    buffer_store_dword v8, v7, s[16:19], 0 offen sc1
F_SIG1:
    s_mov_b64 exec, s[6:7]
F_PHASE2:
    s_mov_b32 s20, s60
    s_mov_b32 s21, s61
    s_mov_b32 s22, 0x200000
    s_mov_b32 s23, 0x00020000
    s_mov_b32 s24, s56
    s_mov_b32 s25, s57
    s_mov_b32 s26, 1024
    s_mov_b32 s27, 0x00020000
    v_lshrrev_b32 v7, 2, v3
    v_lshl_add_u32 v7, v4, 2, v7
    v_lshrrev_b32 v8, 1, v7
    v_and_b32 v8, 3, v8
    v_and_b32 v9, 3, v3
    v_lshlrev_b32 v9, 3, v9
    v_lshl_add_u32 v9, v7, 7, v9
    v_xor_b32 v7, 0, v8
    v_lshl_add_u32 v7, v7, 5, v9
    v_add_u32 v16, s34, v7
    v_add_u32 v20, 81920, v16
    v_add_u32 v24, s35, v7
    v_xor_b32 v7, 1, v8
    v_lshl_add_u32 v7, v7, 5, v9
    v_add_u32 v17, s34, v7
    v_add_u32 v21, 81920, v17
    v_add_u32 v25, s35, v7
    v_xor_b32 v7, 2, v8
    v_lshl_add_u32 v7, v7, 5, v9
    v_add_u32 v18, s34, v7
    v_add_u32 v22, 81920, v18
    v_add_u32 v26, s35, v7
    v_xor_b32 v7, 3, v8
    v_lshl_add_u32 v7, v7, 5, v9
    v_add_u32 v19, s34, v7
    v_add_u32 v23, 81920, v19
    v_add_u32 v27, s35, v7
    s_lshl_b32 s3, s33, 2
    s_mul_i32 s3, s3, 29
    s_add_u32 s3, s3, s30
    s_lshl_b32 s4, s3, 10
    v_lshl_add_u32 v13, v2, 4, s4
    s_lshl_b32 s4, s3, 9
    s_add_u32 s4, s4, 4194304
    v_lshl_add_u32 v14, v2, 3, s4
    v_mov_b32 v15, 154624
    v_mov_b32 v32, 0
    v_mov_b32 v33, 0
    v_mov_b32 v34, 0
    v_mov_b32 v35, 0
    v_mov_b32 v36, 0
    v_mov_b32 v37, 0
    v_mov_b32 v38, 0
    v_mov_b32 v39, 0
    v_mov_b32 v40, 0
    v_mov_b32 v41, 0
    v_mov_b32 v42, 0
    v_mov_b32 v43, 0
    v_mov_b32 v44, 0
    v_mov_b32 v45, 0
    v_mov_b32 v46, 0
    v_mov_b32 v47, 0
    v_mov_b32 v48, 0
    v_mov_b32 v49, 0
    v_mov_b32 v50, 0
    v_mov_b32 v51, 0
    v_mov_b32 v52, 0
    v_mov_b32 v53, 0
    v_mov_b32 v54, 0
    v_mov_b32 v55, 0
    v_mov_b32 v56, 0
    v_mov_b32 v57, 0
    v_mov_b32 v58, 0
    v_mov_b32 v59, 0
    v_mov_b32 v60, 0
    v_mov_b32 v61, 0
    v_mov_b32 v62, 0
    v_mov_b32 v63, 0
    v_mov_b32 v64, 0
    v_mov_b32 v65, 0
    v_mov_b32 v66, 0
    v_mov_b32 v67, 0
    v_mov_b32 v68, 0
    v_mov_b32 v69, 0
    v_mov_b32 v70, 0
    v_mov_b32 v71, 0
    v_mov_b32 v72, 0
    v_mov_b32 v73, 0
    v_mov_b32 v74, 0
    v_mov_b32 v75, 0
    v_mov_b32 v76, 0
    v_mov_b32 v77, 0
    v_mov_b32 v78, 0
    v_mov_b32 v79, 0
    v_mov_b32 v80, 0
    v_mov_b32 v81, 0
    v_mov_b32 v82, 0
    v_mov_b32 v83, 0
    v_mov_b32 v84, 0
    v_mov_b32 v85, 0
    v_mov_b32 v86, 0
    v_mov_b32 v87, 0
    v_mov_b32 v88, 0
    v_mov_b32 v89, 0
    v_mov_b32 v90, 0
    v_mov_b32 v91, 0
    v_mov_b32 v92, 0
    v_mov_b32 v93, 0
    v_mov_b32 v94, 0
    v_mov_b32 v95, 0
    s_lshl_b32 s3, s33, 7
    s_lshl_b32 s4, s30, 2
    s_add_u32 s3, s3, s4
    s_lshl_b32 s3, s3, 10
    s_add_u32 s3, s3, 6291456
    v_lshl_add_u32 v5, v2, 4, s3
    s_cmp_eq_u32 s30, 7
    s_cbranch_scc1 F_SERVICE
    s_add_u32 s3, s30, 0
    s_lshr_b32 s3, s3, 2
    s_lshl_b32 s3, s3, 2
    s_add_u32 s3, s3, 154656
    v_mov_b32 v8, s3
    s_mov_b32 s4, 0
F_HW0:
    ds_read_b32 v9, v8
    s_waitcnt lgkmcnt(0)
    v_readfirstlane_b32 s3, v9
    s_nop 2
    s_cmp_lg_u32 s3, 0
    s_cbranch_scc1 F_HWD0
    s_add_u32 s4, s4, 1
    s_cmp_ge_u32 s4, 480000
    s_cbranch_scc1 F_HWD0
    s_sleep 1
    s_branch F_HW0
F_HWD0:
    s_mov_b32 s39, 0
    buffer_load_dwordx4 v[96:99], v13, s[16:19], s39 offen
    s_mov_b32 s39, 29696
    buffer_load_dwordx4 v[100:103], v13, s[16:19], s39 offen
    s_mov_b32 s39, 59392
    buffer_load_dwordx4 v[104:107], v13, s[16:19], s39 offen
    s_mov_b32 s39, 89088
    buffer_load_dwordx4 v[108:111], v13, s[16:19], s39 offen
    s_mov_b32 s39, 0
    buffer_load_dwordx2 v[136:137], v14, s[16:19], s39 offen
    s_mov_b32 s39, 14848
    buffer_load_dwordx2 v[140:141], v14, s[16:19], s39 offen
    s_mov_b32 s39, 29696
    buffer_load_dwordx2 v[160:161], v14, s[16:19], s39 offen
    s_mov_b32 s39, 44544
    buffer_load_dwordx2 v[164:165], v14, s[16:19], s39 offen
    s_add_u32 s3, s30, 7
    s_lshr_b32 s3, s3, 2
    s_lshl_b32 s3, s3, 2
    s_add_u32 s3, s3, 154656
    v_mov_b32 v8, s3
    s_mov_b32 s4, 0
F_HW1:
    ds_read_b32 v9, v8
    s_waitcnt lgkmcnt(0)
    v_readfirstlane_b32 s3, v9
    s_nop 2
    s_cmp_lg_u32 s3, 0
    s_cbranch_scc1 F_HWD1
    s_add_u32 s4, s4, 1
    s_cmp_ge_u32 s4, 480000
    s_cbranch_scc1 F_HWD1
    s_sleep 1
    s_branch F_HW1
F_HWD1:
    s_mov_b32 s39, 7168
    buffer_load_dwordx4 v[120:123], v13, s[16:19], s39 offen
    s_mov_b32 s39, 36864
    buffer_load_dwordx4 v[124:127], v13, s[16:19], s39 offen
    s_mov_b32 s39, 66560
    buffer_load_dwordx4 v[128:131], v13, s[16:19], s39 offen
    s_mov_b32 s39, 96256
    buffer_load_dwordx4 v[132:135], v13, s[16:19], s39 offen
    s_mov_b32 s39, 3584
    buffer_load_dwordx2 v[138:139], v14, s[16:19], s39 offen
    s_mov_b32 s39, 18432
    buffer_load_dwordx2 v[142:143], v14, s[16:19], s39 offen
    s_mov_b32 s39, 33280
    buffer_load_dwordx2 v[162:163], v14, s[16:19], s39 offen
    s_mov_b32 s39, 48128
    buffer_load_dwordx2 v[166:167], v14, s[16:19], s39 offen
    s_add_u32 s3, s30, 14
    s_lshr_b32 s3, s3, 2
    s_lshl_b32 s3, s3, 2
    s_add_u32 s3, s3, 154656
    v_mov_b32 v8, s3
    s_mov_b32 s4, 0
F_HW2:
    ds_read_b32 v9, v8
    s_waitcnt lgkmcnt(0)
    v_readfirstlane_b32 s3, v9
    s_nop 2
    s_cmp_lg_u32 s3, 0
    s_cbranch_scc1 F_HWD2
    s_add_u32 s4, s4, 1
    s_cmp_ge_u32 s4, 480000
    s_cbranch_scc1 F_HWD2
    s_sleep 1
    s_branch F_HW2
F_HWD2:
    s_mov_b32 s39, 14336
    buffer_load_dwordx4 v[144:147], v13, s[16:19], s39 offen
    s_mov_b32 s39, 44032
    buffer_load_dwordx4 v[148:151], v13, s[16:19], s39 offen
    s_mov_b32 s39, 73728
    buffer_load_dwordx4 v[152:155], v13, s[16:19], s39 offen
    s_mov_b32 s39, 103424
    buffer_load_dwordx4 v[156:159], v13, s[16:19], s39 offen
    s_mov_b32 s39, 7168
    buffer_load_dwordx2 v[112:113], v14, s[16:19], s39 offen
    s_mov_b32 s39, 22016
    buffer_load_dwordx2 v[116:117], v14, s[16:19], s39 offen
    s_mov_b32 s39, 36864
    buffer_load_dwordx2 v[200:201], v14, s[16:19], s39 offen
    s_mov_b32 s39, 51712
    buffer_load_dwordx2 v[204:205], v14, s[16:19], s39 offen
    s_lshl_b32 s3, s33, 10
    s_add_u32 s3, s3, 13041672
    v_lshl_add_u32 v7, v3, 4, s3
    buffer_load_dword v193, v7, s[16:19], 0 offen offset:0
    buffer_load_dword v195, v7, s[16:19], 0 offen offset:256
    buffer_load_dword v197, v7, s[16:19], 0 offen offset:512
    buffer_load_dword v199, v7, s[16:19], 0 offen offset:768
    ds_read_b64_tr_b16 v[168:169], v20 offset:40960
    ds_read_b64_tr_b16 v[170:171], v20 offset:43008
    ds_read_b64_tr_b16 v[172:173], v21 offset:40960
    ds_read_b64_tr_b16 v[174:175], v21 offset:43008
    ds_read_b64_tr_b16 v[176:177], v22 offset:40960
    ds_read_b64_tr_b16 v[178:179], v22 offset:43008
    ds_read_b64_tr_b16 v[180:181], v23 offset:40960
    ds_read_b64_tr_b16 v[182:183], v23 offset:43008
    s_waitcnt vmcnt(20) lgkmcnt(0)
    v_mfma_f32_16x16x32_bf16 v[32:35], v[168:171], v[96:99], v[32:35]
    v_mfma_f32_16x16x32_bf16 v[36:39], v[168:171], v[100:103], v[36:39]
    v_mfma_f32_16x16x32_bf16 v[40:43], v[168:171], v[104:107], v[40:43]
    v_mfma_f32_16x16x32_bf16 v[44:47], v[168:171], v[108:111], v[44:47]
    v_mfma_f32_16x16x32_bf16 v[48:51], v[172:175], v[96:99], v[48:51]
    v_mfma_f32_16x16x32_bf16 v[52:55], v[172:175], v[100:103], v[52:55]
    v_mfma_f32_16x16x32_bf16 v[56:59], v[172:175], v[104:107], v[56:59]
    v_mfma_f32_16x16x32_bf16 v[60:63], v[172:175], v[108:111], v[60:63]
    v_mfma_f32_16x16x32_bf16 v[64:67], v[176:179], v[96:99], v[64:67]
    v_mfma_f32_16x16x32_bf16 v[68:71], v[176:179], v[100:103], v[68:71]
    v_mfma_f32_16x16x32_bf16 v[72:75], v[176:179], v[104:107], v[72:75]
    v_mfma_f32_16x16x32_bf16 v[76:79], v[176:179], v[108:111], v[76:79]
    v_mfma_f32_16x16x32_bf16 v[80:83], v[180:183], v[96:99], v[80:83]
    v_mfma_f32_16x16x32_bf16 v[84:87], v[180:183], v[100:103], v[84:87]
    v_mfma_f32_16x16x32_bf16 v[88:91], v[180:183], v[104:107], v[88:91]
    v_mfma_f32_16x16x32_bf16 v[92:95], v[180:183], v[108:111], v[92:95]
    s_add_u32 s3, s30, 21
    s_lshr_b32 s3, s3, 2
    s_lshl_b32 s3, s3, 2
    s_add_u32 s3, s3, 154656
    v_mov_b32 v8, s3
    s_mov_b32 s4, 0
F_HW3:
    ds_read_b32 v9, v8
    s_waitcnt lgkmcnt(0)
    v_readfirstlane_b32 s3, v9
    s_nop 2
    s_cmp_lg_u32 s3, 0
    s_cbranch_scc1 F_HWD3
    s_add_u32 s4, s4, 1
    s_cmp_ge_u32 s4, 480000
    s_cbranch_scc1 F_HWD3
    s_sleep 1
    s_branch F_HW3
F_HWD3:
    ds_read_b64_tr_b16 v[168:169], v16 offset:0
    ds_read_b64_tr_b16 v[170:171], v16 offset:2048
    ds_read_b64_tr_b16 v[172:173], v17 offset:0
    ds_read_b64_tr_b16 v[174:175], v17 offset:2048
    ds_read_b64_tr_b16 v[176:177], v18 offset:0
    ds_read_b64_tr_b16 v[178:179], v18 offset:2048
    ds_read_b64_tr_b16 v[180:181], v19 offset:0
    ds_read_b64_tr_b16 v[182:183], v19 offset:2048
    ds_read_b64_tr_b16 v[184:185], v24 offset:0
    ds_read_b64_tr_b16 v[186:187], v16 offset:40960
    ds_read_b64_tr_b16 v[188:189], v25 offset:0
    ds_read_b64_tr_b16 v[190:191], v17 offset:40960
    s_mov_b32 s39, 21504
    buffer_load_dwordx4 v[96:99], v13, s[16:19], s39 offen
    s_mov_b32 s39, 51200
    buffer_load_dwordx4 v[100:103], v13, s[16:19], s39 offen
    s_mov_b32 s39, 80896
    buffer_load_dwordx4 v[104:107], v13, s[16:19], s39 offen
    s_mov_b32 s39, 110592
    buffer_load_dwordx4 v[108:111], v13, s[16:19], s39 offen
    s_mov_b32 s39, 10752
    buffer_load_dwordx2 v[114:115], v14, s[16:19], s39 offen
    s_mov_b32 s39, 25600
    buffer_load_dwordx2 v[118:119], v14, s[16:19], s39 offen
    s_mov_b32 s39, 40448
    buffer_load_dwordx2 v[202:203], v14, s[16:19], s39 offen
    s_mov_b32 s39, 55296
    buffer_load_dwordx2 v[206:207], v14, s[16:19], s39 offen
    s_waitcnt vmcnt(20) lgkmcnt(0)
    v_mfma_f32_16x16x32_bf16 v[32:35], v[168:171], v[120:123], v[32:35]
    v_mfma_f32_16x16x32_bf16 v[36:39], v[168:171], v[124:127], v[36:39]
    v_mfma_f32_16x16x32_bf16 v[40:43], v[168:171], v[128:131], v[40:43]
    v_mfma_f32_16x16x32_bf16 v[44:47], v[168:171], v[132:135], v[44:47]
    v_mfma_f32_16x16x32_bf16 v[48:51], v[172:175], v[120:123], v[48:51]
    v_mfma_f32_16x16x32_bf16 v[52:55], v[172:175], v[124:127], v[52:55]
    v_mfma_f32_16x16x32_bf16 v[56:59], v[172:175], v[128:131], v[56:59]
    v_mfma_f32_16x16x32_bf16 v[60:63], v[172:175], v[132:135], v[60:63]
    ds_read_b64_tr_b16 v[168:169], v26 offset:0
    ds_read_b64_tr_b16 v[170:171], v18 offset:40960
    ds_read_b64_tr_b16 v[172:173], v27 offset:0
    ds_read_b64_tr_b16 v[174:175], v19 offset:40960
    v_mfma_f32_16x16x32_bf16 v[64:67], v[176:179], v[120:123], v[64:67]
    v_mfma_f32_16x16x32_bf16 v[68:71], v[176:179], v[124:127], v[68:71]
    v_mfma_f32_16x16x32_bf16 v[72:75], v[176:179], v[128:131], v[72:75]
    v_mfma_f32_16x16x32_bf16 v[76:79], v[176:179], v[132:135], v[76:79]
    v_mfma_f32_16x16x32_bf16 v[80:83], v[180:183], v[120:123], v[80:83]
    v_mfma_f32_16x16x32_bf16 v[84:87], v[180:183], v[124:127], v[84:87]
    v_mfma_f32_16x16x32_bf16 v[88:91], v[180:183], v[128:131], v[88:91]
    v_mfma_f32_16x16x32_bf16 v[92:95], v[180:183], v[132:135], v[92:95]
    v_mfma_f32_16x16x32_bf16 v[32:35], v[184:187], v[136:139], v[32:35]
    v_mfma_f32_16x16x32_bf16 v[36:39], v[184:187], v[140:143], v[36:39]
    v_mfma_f32_16x16x32_bf16 v[40:43], v[184:187], v[160:163], v[40:43]
    v_mfma_f32_16x16x32_bf16 v[44:47], v[184:187], v[164:167], v[44:47]
    v_mfma_f32_16x16x32_bf16 v[48:51], v[188:191], v[136:139], v[48:51]
    v_mfma_f32_16x16x32_bf16 v[52:55], v[188:191], v[140:143], v[52:55]
    v_mfma_f32_16x16x32_bf16 v[56:59], v[188:191], v[160:163], v[56:59]
    v_mfma_f32_16x16x32_bf16 v[60:63], v[188:191], v[164:167], v[60:63]
    s_waitcnt lgkmcnt(0)
    v_mfma_f32_16x16x32_bf16 v[64:67], v[168:171], v[136:139], v[64:67]
    v_mfma_f32_16x16x32_bf16 v[68:71], v[168:171], v[140:143], v[68:71]
    v_mfma_f32_16x16x32_bf16 v[72:75], v[168:171], v[160:163], v[72:75]
    v_mfma_f32_16x16x32_bf16 v[76:79], v[168:171], v[164:167], v[76:79]
    v_mfma_f32_16x16x32_bf16 v[80:83], v[172:175], v[136:139], v[80:83]
    v_mfma_f32_16x16x32_bf16 v[84:87], v[172:175], v[140:143], v[84:87]
    v_mfma_f32_16x16x32_bf16 v[88:91], v[172:175], v[160:163], v[88:91]
    v_mfma_f32_16x16x32_bf16 v[92:95], v[172:175], v[164:167], v[92:95]
    ds_read_b64_tr_b16 v[168:169], v20 offset:0
    ds_read_b64_tr_b16 v[170:171], v20 offset:2048
    ds_read_b64_tr_b16 v[172:173], v21 offset:0
    ds_read_b64_tr_b16 v[174:175], v21 offset:2048
    ds_read_b64_tr_b16 v[176:177], v22 offset:0
    ds_read_b64_tr_b16 v[178:179], v22 offset:2048
    ds_read_b64_tr_b16 v[180:181], v23 offset:0
    ds_read_b64_tr_b16 v[182:183], v23 offset:2048
    v_and_b32 v8, 7, v2
    v_lshlrev_b32 v8, 2, v8
    v_add_u32 v8, 154688, v8
    s_mov_b32 s4, 0
F_QW:
    ds_read_b32 v9, v8
    s_waitcnt lgkmcnt(0)
    v_cmp_ne_u32 vcc, 0, v9
    s_nop 2
    s_cmp_eq_u64 vcc, -1
    s_cbranch_scc1 F_QWD
    s_add_u32 s4, s4, 1
    s_cmp_ge_u32 s4, 480000
    s_cbranch_scc1 F_QWD
    s_sleep 1
    s_branch F_QW
F_QWD:
    s_mov_b32 s39, 0
    buffer_load_dwordx4 v[120:123], v5, s[16:19], s39 offen
    s_mov_b32 s39, 32768
    buffer_load_dwordx4 v[124:127], v5, s[16:19], s39 offen
    s_mov_b32 s39, 65536
    buffer_load_dwordx4 v[128:131], v5, s[16:19], s39 offen
    s_mov_b32 s39, 98304
    buffer_load_dwordx4 v[132:135], v5, s[16:19], s39 offen
    s_mov_b32 s39, 1024
    buffer_load_dwordx4 v[136:139], v5, s[16:19], s39 offen
    s_mov_b32 s39, 33792
    buffer_load_dwordx4 v[140:143], v5, s[16:19], s39 offen
    s_waitcnt vmcnt(18) lgkmcnt(0)
    v_mfma_f32_16x16x32_bf16 v[32:35], v[168:171], v[144:147], v[32:35]
    v_mfma_f32_16x16x32_bf16 v[36:39], v[168:171], v[148:151], v[36:39]
    v_mfma_f32_16x16x32_bf16 v[40:43], v[168:171], v[152:155], v[40:43]
    v_mfma_f32_16x16x32_bf16 v[44:47], v[168:171], v[156:159], v[44:47]
    v_mfma_f32_16x16x32_bf16 v[48:51], v[172:175], v[144:147], v[48:51]
    v_mfma_f32_16x16x32_bf16 v[52:55], v[172:175], v[148:151], v[52:55]
    v_mfma_f32_16x16x32_bf16 v[56:59], v[172:175], v[152:155], v[56:59]
    v_mfma_f32_16x16x32_bf16 v[60:63], v[172:175], v[156:159], v[60:63]
    v_mfma_f32_16x16x32_bf16 v[64:67], v[176:179], v[144:147], v[64:67]
    v_mfma_f32_16x16x32_bf16 v[68:71], v[176:179], v[148:151], v[68:71]
    v_mfma_f32_16x16x32_bf16 v[72:75], v[176:179], v[152:155], v[72:75]
    v_mfma_f32_16x16x32_bf16 v[76:79], v[176:179], v[156:159], v[76:79]
    v_mfma_f32_16x16x32_bf16 v[80:83], v[180:183], v[144:147], v[80:83]
    v_mfma_f32_16x16x32_bf16 v[84:87], v[180:183], v[148:151], v[84:87]
    v_mfma_f32_16x16x32_bf16 v[88:91], v[180:183], v[152:155], v[88:91]
    v_mfma_f32_16x16x32_bf16 v[92:95], v[180:183], v[156:159], v[92:95]
    s_mov_b32 s39, 66560
    buffer_load_dwordx4 v[144:147], v5, s[16:19], s39 offen
    s_mov_b32 s39, 99328
    buffer_load_dwordx4 v[148:151], v5, s[16:19], s39 offen
    s_mov_b32 s39, 2048
    buffer_load_dwordx4 v[152:155], v5, s[16:19], s39 offen
    s_mov_b32 s39, 34816
    buffer_load_dwordx4 v[156:159], v5, s[16:19], s39 offen
    s_mov_b32 s39, 67584
    buffer_load_dwordx4 v[160:163], v5, s[16:19], s39 offen
    s_mov_b32 s39, 100352
    buffer_load_dwordx4 v[164:167], v5, s[16:19], s39 offen
    ds_read_b64_tr_b16 v[168:169], v16 offset:43008
    ds_read_b64_tr_b16 v[170:171], v24 offset:2048
    ds_read_b64_tr_b16 v[172:173], v17 offset:43008
    ds_read_b64_tr_b16 v[174:175], v25 offset:2048
    ds_read_b64_tr_b16 v[176:177], v18 offset:43008
    ds_read_b64_tr_b16 v[178:179], v26 offset:2048
    ds_read_b64_tr_b16 v[180:181], v19 offset:43008
    ds_read_b64_tr_b16 v[182:183], v27 offset:2048
    s_waitcnt vmcnt(12) lgkmcnt(0)
    v_mfma_f32_16x16x32_bf16 v[32:35], v[240:243], v[96:99], v[32:35]
    v_mfma_f32_16x16x32_bf16 v[36:39], v[240:243], v[100:103], v[36:39]
    v_mfma_f32_16x16x32_bf16 v[40:43], v[240:243], v[104:107], v[40:43]
    v_mfma_f32_16x16x32_bf16 v[44:47], v[240:243], v[108:111], v[44:47]
    v_mfma_f32_16x16x32_bf16 v[48:51], v[244:247], v[96:99], v[48:51]
    v_mfma_f32_16x16x32_bf16 v[52:55], v[244:247], v[100:103], v[52:55]
    v_mfma_f32_16x16x32_bf16 v[56:59], v[244:247], v[104:107], v[56:59]
    v_mfma_f32_16x16x32_bf16 v[60:63], v[244:247], v[108:111], v[60:63]
    v_mfma_f32_16x16x32_bf16 v[64:67], v[248:251], v[96:99], v[64:67]
    v_mfma_f32_16x16x32_bf16 v[68:71], v[248:251], v[100:103], v[68:71]
    v_mfma_f32_16x16x32_bf16 v[72:75], v[248:251], v[104:107], v[72:75]
    v_mfma_f32_16x16x32_bf16 v[76:79], v[248:251], v[108:111], v[76:79]
    v_mfma_f32_16x16x32_bf16 v[80:83], v[252:255], v[96:99], v[80:83]
    v_mfma_f32_16x16x32_bf16 v[84:87], v[252:255], v[100:103], v[84:87]
    v_mfma_f32_16x16x32_bf16 v[88:91], v[252:255], v[104:107], v[88:91]
    v_mfma_f32_16x16x32_bf16 v[92:95], v[252:255], v[108:111], v[92:95]
    v_mfma_f32_16x16x32_bf16 v[32:35], v[168:171], v[112:115], v[32:35]
    v_mfma_f32_16x16x32_bf16 v[36:39], v[168:171], v[116:119], v[36:39]
    v_mfma_f32_16x16x32_bf16 v[40:43], v[168:171], v[200:203], v[40:43]
    v_mfma_f32_16x16x32_bf16 v[44:47], v[168:171], v[204:207], v[44:47]
    v_mfma_f32_16x16x32_bf16 v[48:51], v[172:175], v[112:115], v[48:51]
    v_mfma_f32_16x16x32_bf16 v[52:55], v[172:175], v[116:119], v[52:55]
    v_mfma_f32_16x16x32_bf16 v[56:59], v[172:175], v[200:203], v[56:59]
    v_mfma_f32_16x16x32_bf16 v[60:63], v[172:175], v[204:207], v[60:63]
    v_mfma_f32_16x16x32_bf16 v[64:67], v[176:179], v[112:115], v[64:67]
    v_mfma_f32_16x16x32_bf16 v[68:71], v[176:179], v[116:119], v[68:71]
    v_mfma_f32_16x16x32_bf16 v[72:75], v[176:179], v[200:203], v[72:75]
    v_mfma_f32_16x16x32_bf16 v[76:79], v[176:179], v[204:207], v[76:79]
    v_mfma_f32_16x16x32_bf16 v[80:83], v[180:183], v[112:115], v[80:83]
    v_mfma_f32_16x16x32_bf16 v[84:87], v[180:183], v[116:119], v[84:87]
    v_mfma_f32_16x16x32_bf16 v[88:91], v[180:183], v[200:203], v[88:91]
    v_mfma_f32_16x16x32_bf16 v[92:95], v[180:183], v[204:207], v[92:95]
    s_mov_b32 s39, 3072
    buffer_load_dwordx4 v[96:99], v5, s[16:19], s39 offen
    s_mov_b32 s39, 35840
    buffer_load_dwordx4 v[100:103], v5, s[16:19], s39 offen
    s_mov_b32 s39, 68608
    buffer_load_dwordx4 v[104:107], v5, s[16:19], s39 offen
    s_mov_b32 s39, 101376
    buffer_load_dwordx4 v[108:111], v5, s[16:19], s39 offen
    s_mov_b32 s4, 0
F_LWb:
    ds_read_b32 v9, v15 offset:4
    s_waitcnt lgkmcnt(0)
    v_readfirstlane_b32 s3, v9
    s_nop 2
    s_cmp_lg_u32 s3, 0
    s_cbranch_scc1 F_LWDb
    s_add_u32 s4, s4, 1
    s_cmp_ge_u32 s4, 480000
    s_cbranch_scc1 F_LWDb
    s_sleep 1
    s_branch F_LWb
F_LWDb:
    s_branch F_KVLD
F_SERVICE:
    s_lshl_b32 s5, s33, 7
    s_add_u32 s5, s5, 13107200
    v_lshl_add_u32 v8, v3, 2, s5
    v_lshlrev_b32 v7, 2, v3
    v_add_u32 v7, 154656, v7
    s_mov_b32 s4, 0
F_SV:
    buffer_load_dword v9, v8, s[16:19], 0 offen sc0 sc1
    s_waitcnt vmcnt(0)
    ds_write_b32 v7, v9
    v_cmp_ne_u32 vcc, 0, v9
    s_nop 2
    s_cmp_eq_u64 vcc, -1
    s_cbranch_scc1 F_SVD
    s_add_u32 s4, s4, 1
    s_cmp_ge_u32 s4, 60000
    s_cbranch_scc1 F_SVD
    s_sleep 1
    s_branch F_SV
F_SVD:
    s_mov_b32 s39, 0
    buffer_load_dwordx4 v[120:123], v5, s[16:19], s39 offen
    s_mov_b32 s39, 32768
    buffer_load_dwordx4 v[124:127], v5, s[16:19], s39 offen
    s_mov_b32 s39, 65536
    buffer_load_dwordx4 v[128:131], v5, s[16:19], s39 offen
    s_mov_b32 s39, 98304
    buffer_load_dwordx4 v[132:135], v5, s[16:19], s39 offen
    s_mov_b32 s39, 1024
    buffer_load_dwordx4 v[136:139], v5, s[16:19], s39 offen
    s_mov_b32 s39, 33792
    buffer_load_dwordx4 v[140:143], v5, s[16:19], s39 offen
    s_mov_b32 s39, 66560
    buffer_load_dwordx4 v[144:147], v5, s[16:19], s39 offen
    s_mov_b32 s39, 99328
    buffer_load_dwordx4 v[148:151], v5, s[16:19], s39 offen
    s_mov_b32 s39, 2048
    buffer_load_dwordx4 v[152:155], v5, s[16:19], s39 offen
    s_mov_b32 s39, 34816
    buffer_load_dwordx4 v[156:159], v5, s[16:19], s39 offen
    s_mov_b32 s39, 67584
    buffer_load_dwordx4 v[160:163], v5, s[16:19], s39 offen
    s_mov_b32 s39, 100352
    buffer_load_dwordx4 v[164:167], v5, s[16:19], s39 offen
    s_mov_b32 s39, 21504
    buffer_load_dwordx4 v[96:99], v13, s[16:19], s39 offen
    s_mov_b32 s39, 51200
    buffer_load_dwordx4 v[100:103], v13, s[16:19], s39 offen
    s_mov_b32 s39, 80896
    buffer_load_dwordx4 v[104:107], v13, s[16:19], s39 offen
    s_mov_b32 s39, 110592
    buffer_load_dwordx4 v[108:111], v13, s[16:19], s39 offen
    s_lshl_b32 s3, s33, 10
    s_add_u32 s3, s3, 13041672
    v_lshl_add_u32 v7, v3, 4, s3
    buffer_load_dword v193, v7, s[16:19], 0 offen offset:0
    buffer_load_dword v195, v7, s[16:19], 0 offen offset:256
    buffer_load_dword v197, v7, s[16:19], 0 offen offset:512
    buffer_load_dword v199, v7, s[16:19], 0 offen offset:768
    s_waitcnt vmcnt(4)
    v_mfma_f32_16x16x32_bf16 v[32:35], v[240:243], v[96:99], v[32:35]
    v_mfma_f32_16x16x32_bf16 v[36:39], v[240:243], v[100:103], v[36:39]
    v_mfma_f32_16x16x32_bf16 v[40:43], v[240:243], v[104:107], v[40:43]
    v_mfma_f32_16x16x32_bf16 v[44:47], v[240:243], v[108:111], v[44:47]
    v_mfma_f32_16x16x32_bf16 v[48:51], v[244:247], v[96:99], v[48:51]
    v_mfma_f32_16x16x32_bf16 v[52:55], v[244:247], v[100:103], v[52:55]
    v_mfma_f32_16x16x32_bf16 v[56:59], v[244:247], v[104:107], v[56:59]
    v_mfma_f32_16x16x32_bf16 v[60:63], v[244:247], v[108:111], v[60:63]
    v_mfma_f32_16x16x32_bf16 v[64:67], v[248:251], v[96:99], v[64:67]
    v_mfma_f32_16x16x32_bf16 v[68:71], v[248:251], v[100:103], v[68:71]
    v_mfma_f32_16x16x32_bf16 v[72:75], v[248:251], v[104:107], v[72:75]
    v_mfma_f32_16x16x32_bf16 v[76:79], v[248:251], v[108:111], v[76:79]
    v_mfma_f32_16x16x32_bf16 v[80:83], v[252:255], v[96:99], v[80:83]
    v_mfma_f32_16x16x32_bf16 v[84:87], v[252:255], v[100:103], v[84:87]
    v_mfma_f32_16x16x32_bf16 v[88:91], v[252:255], v[104:107], v[88:91]
    v_mfma_f32_16x16x32_bf16 v[92:95], v[252:255], v[108:111], v[92:95]
    s_mov_b32 s39, 3072
    buffer_load_dwordx4 v[96:99], v5, s[16:19], s39 offen
    s_mov_b32 s39, 35840
    buffer_load_dwordx4 v[100:103], v5, s[16:19], s39 offen
    s_mov_b32 s39, 68608
    buffer_load_dwordx4 v[104:107], v5, s[16:19], s39 offen
    s_mov_b32 s39, 101376
    buffer_load_dwordx4 v[108:111], v5, s[16:19], s39 offen
    s_mov_b32 s4, 0
    s_lshl_b32 s5, s33, 8
    s_add_u32 s5, s5, 13115392
    v_mov_b32 v8, s5
F_GWb:
    buffer_load_dword v9, v8, s[16:19], 0 offen sc0 sc1
    s_waitcnt vmcnt(0)
    v_cmp_ne_u32 vcc, 0, v9
    s_nop 2
    s_cmp_eq_u64 vcc, -1
    s_cbranch_scc1 F_GWDb
    s_add_u32 s4, s4, 1
    s_cmp_ge_u32 s4, 60000
    s_cbranch_scc1 F_GWDb
    s_sleep 4
    s_branch F_GWb
F_GWDb:
    v_mov_b32 v9, 1
    ds_write_b32 v15, v9 offset:4
F_KVLD:
    s_mul_i32 s3, s30, 8704
    s_add_u32 s3, s3, 10485760
    v_lshl_add_u32 v7, v2, 2, s3
    v_add_u32 v9, 4096, v7
    s_add_u32 s3, s3, 8192
    v_lshl_add_u32 v8, v4, 5, s3
    buffer_load_dword v168, v7, s[16:19], 0 offen offset:0
    buffer_load_dword v169, v7, s[16:19], 0 offen offset:256
    buffer_load_dword v170, v7, s[16:19], 0 offen offset:512
    buffer_load_dword v171, v7, s[16:19], 0 offen offset:768
    buffer_load_dword v240, v7, s[16:19], 0 offen offset:1024
    buffer_load_dword v241, v7, s[16:19], 0 offen offset:1280
    buffer_load_dword v242, v7, s[16:19], 0 offen offset:1536
    buffer_load_dword v243, v7, s[16:19], 0 offen offset:1792
    buffer_load_dwordx4 v[16:19], v8, s[16:19], 0 offen offset:0
    buffer_load_dwordx4 v[112:115], v8, s[16:19], 0 offen offset:16
    buffer_load_dword v174, v7, s[16:19], 0 offen offset:2048
    buffer_load_dword v175, v7, s[16:19], 0 offen offset:2304
    buffer_load_dword v176, v7, s[16:19], 0 offen offset:2560
    buffer_load_dword v177, v7, s[16:19], 0 offen offset:2816
    buffer_load_dword v244, v7, s[16:19], 0 offen offset:3072
    buffer_load_dword v245, v7, s[16:19], 0 offen offset:3328
    buffer_load_dword v246, v7, s[16:19], 0 offen offset:3584
    buffer_load_dword v247, v7, s[16:19], 0 offen offset:3840
    buffer_load_dwordx4 v[20:23], v8, s[16:19], 0 offen offset:128
    buffer_load_dwordx4 v[116:119], v8, s[16:19], 0 offen offset:144
    buffer_load_dword v180, v9, s[16:19], 0 offen offset:0
    buffer_load_dword v181, v9, s[16:19], 0 offen offset:256
    buffer_load_dword v182, v9, s[16:19], 0 offen offset:512
    buffer_load_dword v183, v9, s[16:19], 0 offen offset:768
    buffer_load_dword v248, v9, s[16:19], 0 offen offset:1024
    buffer_load_dword v249, v9, s[16:19], 0 offen offset:1280
    buffer_load_dword v250, v9, s[16:19], 0 offen offset:1536
    buffer_load_dword v251, v9, s[16:19], 0 offen offset:1792
    buffer_load_dwordx4 v[24:27], v8, s[16:19], 0 offen offset:256
    buffer_load_dwordx4 v[200:203], v8, s[16:19], 0 offen offset:272
    buffer_load_dword v186, v9, s[16:19], 0 offen offset:2048
    buffer_load_dword v187, v9, s[16:19], 0 offen offset:2304
    buffer_load_dword v188, v9, s[16:19], 0 offen offset:2560
    buffer_load_dword v189, v9, s[16:19], 0 offen offset:2816
    buffer_load_dword v252, v9, s[16:19], 0 offen offset:3072
    buffer_load_dword v253, v9, s[16:19], 0 offen offset:3328
    buffer_load_dword v254, v9, s[16:19], 0 offen offset:3584
    buffer_load_dword v255, v9, s[16:19], 0 offen offset:3840
    buffer_load_dwordx4 v[28:31], v8, s[16:19], 0 offen offset:384
    buffer_load_dwordx2 v[172:173], v8, s[16:19], 0 offen offset:400
    buffer_load_dwordx2 v[178:179], v8, s[16:19], 0 offen offset:408
    s_waitcnt vmcnt(31)
    v_cvt_pk_bf16_f32 v168, v168, v169
    v_cvt_pk_bf16_f32 v169, v170, v171
    v_cvt_pk_bf16_f32 v170, v240, v241
    v_cvt_pk_bf16_f32 v171, v242, v243
    v_cvt_pk_bf16_f32 v16, v16, v17
    v_cvt_pk_bf16_f32 v17, v18, v19
    v_cvt_pk_bf16_f32 v18, v112, v113
    v_cvt_pk_bf16_f32 v19, v114, v115
    s_waitcnt vmcnt(21)
    v_cvt_pk_bf16_f32 v174, v174, v175
    v_cvt_pk_bf16_f32 v175, v176, v177
    v_cvt_pk_bf16_f32 v176, v244, v245
    v_cvt_pk_bf16_f32 v177, v246, v247
    v_cvt_pk_bf16_f32 v20, v20, v21
    v_cvt_pk_bf16_f32 v21, v22, v23
    v_cvt_pk_bf16_f32 v22, v116, v117
    v_cvt_pk_bf16_f32 v23, v118, v119
F_OPART:
    v_sub_f32 v192, 1.0, v193
    v_sub_f32 v194, 1.0, v195
    v_sub_f32 v196, 1.0, v197
    v_sub_f32 v198, 1.0, v199
    v_lshl_add_u32 v7, v2, 4, s34
    v_add_u32 v9, 81920, v7
    v_mfma_f32_16x16x32_bf16 v[240:243], v[168:171], v[120:123], 0
    v_mfma_f32_16x16x32_bf16 v[112:115], v[16:19], v[120:123], 0
    v_mfma_f32_16x16x32_bf16 v[244:247], v[174:177], v[136:139], 0
    v_mfma_f32_16x16x32_bf16 v[116:119], v[20:23], v[136:139], 0
    s_nop 5
    v_add_f32 v112, 0x358637bd, v112
    s_nop 0
    v_add_f32 v116, 0x358637bd, v116
    v_rcp_f32 v112, v112
    v_rcp_f32 v116, v116
    v_mul_f32 v112, v112, v193
    v_mul_f32 v116, v116, v193
    v_pk_mul_f32 v[240:241], v[240:241], v[112:113] op_sel_hi:[1,0]
    v_pk_mul_f32 v[242:243], v[242:243], v[112:113] op_sel_hi:[1,0]
    v_pk_mul_f32 v[244:245], v[244:245], v[116:117] op_sel_hi:[1,0]
    v_pk_mul_f32 v[246:247], v[246:247], v[116:117] op_sel_hi:[1,0]
    v_cvt_pk_bf16_f32 v240, v240, v241
    v_cvt_pk_bf16_f32 v241, v242, v243
    v_cvt_pk_bf16_f32 v242, v244, v245
    v_cvt_pk_bf16_f32 v243, v246, v247
    s_nop 1
    v_mfma_f32_16x16x32_bf16 v[32:35], v[208:211], v[240:243], v[32:35]
    v_mfma_f32_16x16x32_bf16 v[48:51], v[212:215], v[240:243], v[48:51]
    v_mfma_f32_16x16x32_bf16 v[64:67], v[216:219], v[240:243], v[64:67]
    v_mfma_f32_16x16x32_bf16 v[80:83], v[220:223], v[240:243], v[80:83]
    v_mfma_f32_16x16x32_bf16 v[240:243], v[168:171], v[124:127], 0
    v_mfma_f32_16x16x32_bf16 v[112:115], v[16:19], v[124:127], 0
    v_mfma_f32_16x16x32_bf16 v[244:247], v[174:177], v[140:143], 0
    v_mfma_f32_16x16x32_bf16 v[116:119], v[20:23], v[140:143], 0
    s_nop 5
    v_add_f32 v112, 0x358637bd, v112
    s_nop 0
    v_add_f32 v116, 0x358637bd, v116
    v_rcp_f32 v112, v112
    v_rcp_f32 v116, v116
    v_mul_f32 v112, v112, v195
    v_mul_f32 v116, v116, v195
    v_pk_mul_f32 v[240:241], v[240:241], v[112:113] op_sel_hi:[1,0]
    v_pk_mul_f32 v[242:243], v[242:243], v[112:113] op_sel_hi:[1,0]
    v_pk_mul_f32 v[244:245], v[244:245], v[116:117] op_sel_hi:[1,0]
    v_pk_mul_f32 v[246:247], v[246:247], v[116:117] op_sel_hi:[1,0]
    v_cvt_pk_bf16_f32 v240, v240, v241
    v_cvt_pk_bf16_f32 v241, v242, v243
    v_cvt_pk_bf16_f32 v242, v244, v245
    v_cvt_pk_bf16_f32 v243, v246, v247
    s_nop 1
    v_mfma_f32_16x16x32_bf16 v[36:39], v[208:211], v[240:243], v[36:39]
    v_mfma_f32_16x16x32_bf16 v[52:55], v[212:215], v[240:243], v[52:55]
    v_mfma_f32_16x16x32_bf16 v[68:71], v[216:219], v[240:243], v[68:71]
    v_mfma_f32_16x16x32_bf16 v[84:87], v[220:223], v[240:243], v[84:87]
    v_mfma_f32_16x16x32_bf16 v[240:243], v[168:171], v[128:131], 0
    v_mfma_f32_16x16x32_bf16 v[112:115], v[16:19], v[128:131], 0
    v_mfma_f32_16x16x32_bf16 v[244:247], v[174:177], v[144:147], 0
    v_mfma_f32_16x16x32_bf16 v[116:119], v[20:23], v[144:147], 0
    s_nop 5
    v_add_f32 v112, 0x358637bd, v112
    s_nop 0
    v_add_f32 v116, 0x358637bd, v116
    v_rcp_f32 v112, v112
    v_rcp_f32 v116, v116
    v_mul_f32 v112, v112, v197
    v_mul_f32 v116, v116, v197
    v_pk_mul_f32 v[240:241], v[240:241], v[112:113] op_sel_hi:[1,0]
    v_pk_mul_f32 v[242:243], v[242:243], v[112:113] op_sel_hi:[1,0]
    v_pk_mul_f32 v[244:245], v[244:245], v[116:117] op_sel_hi:[1,0]
    v_pk_mul_f32 v[246:247], v[246:247], v[116:117] op_sel_hi:[1,0]
    v_cvt_pk_bf16_f32 v240, v240, v241
    v_cvt_pk_bf16_f32 v241, v242, v243
    v_cvt_pk_bf16_f32 v242, v244, v245
    v_cvt_pk_bf16_f32 v243, v246, v247
    s_nop 1
    v_mfma_f32_16x16x32_bf16 v[40:43], v[208:211], v[240:243], v[40:43]
    v_mfma_f32_16x16x32_bf16 v[56:59], v[212:215], v[240:243], v[56:59]
    v_mfma_f32_16x16x32_bf16 v[72:75], v[216:219], v[240:243], v[72:75]
    v_mfma_f32_16x16x32_bf16 v[88:91], v[220:223], v[240:243], v[88:91]
    v_mfma_f32_16x16x32_bf16 v[240:243], v[168:171], v[132:135], 0
    v_mfma_f32_16x16x32_bf16 v[112:115], v[16:19], v[132:135], 0
    v_mfma_f32_16x16x32_bf16 v[244:247], v[174:177], v[148:151], 0
    v_mfma_f32_16x16x32_bf16 v[116:119], v[20:23], v[148:151], 0
    s_nop 5
    v_add_f32 v112, 0x358637bd, v112
    s_nop 0
    v_add_f32 v116, 0x358637bd, v116
    v_rcp_f32 v112, v112
    v_rcp_f32 v116, v116
    v_mul_f32 v112, v112, v199
    v_mul_f32 v116, v116, v199
    v_pk_mul_f32 v[240:241], v[240:241], v[112:113] op_sel_hi:[1,0]
    v_pk_mul_f32 v[242:243], v[242:243], v[112:113] op_sel_hi:[1,0]
    v_pk_mul_f32 v[244:245], v[244:245], v[116:117] op_sel_hi:[1,0]
    v_pk_mul_f32 v[246:247], v[246:247], v[116:117] op_sel_hi:[1,0]
    v_cvt_pk_bf16_f32 v240, v240, v241
    v_cvt_pk_bf16_f32 v241, v242, v243
    v_cvt_pk_bf16_f32 v242, v244, v245
    v_cvt_pk_bf16_f32 v243, v246, v247
    s_nop 1
    v_mfma_f32_16x16x32_bf16 v[44:47], v[208:211], v[240:243], v[44:47]
    v_mfma_f32_16x16x32_bf16 v[60:63], v[212:215], v[240:243], v[60:63]
    v_mfma_f32_16x16x32_bf16 v[76:79], v[216:219], v[240:243], v[76:79]
    v_mfma_f32_16x16x32_bf16 v[92:95], v[220:223], v[240:243], v[92:95]
    s_waitcnt vmcnt(11)
    v_cvt_pk_bf16_f32 v180, v180, v181
    v_cvt_pk_bf16_f32 v181, v182, v183
    v_cvt_pk_bf16_f32 v182, v248, v249
    v_cvt_pk_bf16_f32 v183, v250, v251
    v_cvt_pk_bf16_f32 v24, v24, v25
    v_cvt_pk_bf16_f32 v25, v26, v27
    v_cvt_pk_bf16_f32 v26, v200, v201
    v_cvt_pk_bf16_f32 v27, v202, v203
    s_waitcnt vmcnt(0)
    v_cvt_pk_bf16_f32 v186, v186, v187
    v_cvt_pk_bf16_f32 v187, v188, v189
    v_cvt_pk_bf16_f32 v188, v252, v253
    v_cvt_pk_bf16_f32 v189, v254, v255
    v_cvt_pk_bf16_f32 v28, v28, v29
    v_cvt_pk_bf16_f32 v29, v30, v31
    v_cvt_pk_bf16_f32 v30, v172, v173
    v_cvt_pk_bf16_f32 v31, v178, v179
    v_mfma_f32_16x16x32_bf16 v[240:243], v[180:183], v[152:155], 0
    v_mfma_f32_16x16x32_bf16 v[112:115], v[24:27], v[152:155], 0
    v_mfma_f32_16x16x32_bf16 v[244:247], v[186:189], v[96:99], 0
    v_mfma_f32_16x16x32_bf16 v[116:119], v[28:31], v[96:99], 0
    v_mfma_f32_16x16x32_bf16 v[248:251], v[180:183], v[156:159], 0
    v_mfma_f32_16x16x32_bf16 v[200:203], v[24:27], v[156:159], 0
    v_mfma_f32_16x16x32_bf16 v[252:255], v[186:189], v[100:103], 0
    v_mfma_f32_16x16x32_bf16 v[204:207], v[28:31], v[100:103], 0
    s_nop 1
    v_add_f32 v112, 0x358637bd, v112
    s_nop 0
    v_add_f32 v116, 0x358637bd, v116
    v_rcp_f32 v112, v112
    v_rcp_f32 v116, v116
    v_mul_f32 v112, v112, v193
    v_mul_f32 v116, v116, v193
    v_pk_mul_f32 v[240:241], v[240:241], v[112:113] op_sel_hi:[1,0]
    v_pk_mul_f32 v[242:243], v[242:243], v[112:113] op_sel_hi:[1,0]
    v_pk_mul_f32 v[244:245], v[244:245], v[116:117] op_sel_hi:[1,0]
    v_pk_mul_f32 v[246:247], v[246:247], v[116:117] op_sel_hi:[1,0]
    v_cvt_pk_bf16_f32 v240, v240, v241
    v_cvt_pk_bf16_f32 v241, v242, v243
    v_cvt_pk_bf16_f32 v242, v244, v245
    v_cvt_pk_bf16_f32 v243, v246, v247
    s_nop 1
    v_mfma_f32_16x16x32_bf16 v[32:35], v[224:227], v[240:243], v[32:35]
    v_mfma_f32_16x16x32_bf16 v[48:51], v[228:231], v[240:243], v[48:51]
    v_mfma_f32_16x16x32_bf16 v[64:67], v[232:235], v[240:243], v[64:67]
    v_mfma_f32_16x16x32_bf16 v[80:83], v[236:239], v[240:243], v[80:83]
    v_mfma_f32_16x16x32_bf16 v[240:243], v[180:183], v[160:163], 0
    v_mfma_f32_16x16x32_bf16 v[112:115], v[24:27], v[160:163], 0
    v_mfma_f32_16x16x32_bf16 v[244:247], v[186:189], v[104:107], 0
    v_mfma_f32_16x16x32_bf16 v[116:119], v[28:31], v[104:107], 0
    v_add_f32 v200, 0x358637bd, v200
    v_add_f32 v204, 0x358637bd, v204
    v_rcp_f32 v200, v200
    v_rcp_f32 v204, v204
    v_mul_f32 v200, v200, v195
    v_mul_f32 v204, v204, v195
    v_pk_mul_f32 v[248:249], v[248:249], v[200:201] op_sel_hi:[1,0]
    v_pk_mul_f32 v[250:251], v[250:251], v[200:201] op_sel_hi:[1,0]
    v_pk_mul_f32 v[252:253], v[252:253], v[204:205] op_sel_hi:[1,0]
    v_pk_mul_f32 v[254:255], v[254:255], v[204:205] op_sel_hi:[1,0]
    v_cvt_pk_bf16_f32 v248, v248, v249
    v_cvt_pk_bf16_f32 v249, v250, v251
    v_cvt_pk_bf16_f32 v250, v252, v253
    v_cvt_pk_bf16_f32 v251, v254, v255
    s_nop 1
    ds_write_b128 v7, v[32:35] offset:0
    ds_write_b128 v7, v[48:51] offset:40960
    ds_write_b128 v9, v[64:67] offset:0
    ds_write_b128 v9, v[80:83] offset:40960
    v_mfma_f32_16x16x32_bf16 v[36:39], v[224:227], v[248:251], v[36:39]
    v_mfma_f32_16x16x32_bf16 v[52:55], v[228:231], v[248:251], v[52:55]
    v_mfma_f32_16x16x32_bf16 v[68:71], v[232:235], v[248:251], v[68:71]
    v_mfma_f32_16x16x32_bf16 v[84:87], v[236:239], v[248:251], v[84:87]
    v_mfma_f32_16x16x32_bf16 v[248:251], v[180:183], v[164:167], 0
    v_mfma_f32_16x16x32_bf16 v[200:203], v[24:27], v[164:167], 0
    v_mfma_f32_16x16x32_bf16 v[252:255], v[186:189], v[108:111], 0
    v_mfma_f32_16x16x32_bf16 v[204:207], v[28:31], v[108:111], 0
    v_add_f32 v112, 0x358637bd, v112
    v_add_f32 v116, 0x358637bd, v116
    v_rcp_f32 v112, v112
    v_rcp_f32 v116, v116
    v_mul_f32 v112, v112, v197
    v_mul_f32 v116, v116, v197
    v_pk_mul_f32 v[240:241], v[240:241], v[112:113] op_sel_hi:[1,0]
    v_pk_mul_f32 v[242:243], v[242:243], v[112:113] op_sel_hi:[1,0]
    v_pk_mul_f32 v[244:245], v[244:245], v[116:117] op_sel_hi:[1,0]
    v_pk_mul_f32 v[246:247], v[246:247], v[116:117] op_sel_hi:[1,0]
    v_cvt_pk_bf16_f32 v240, v240, v241
    v_cvt_pk_bf16_f32 v241, v242, v243
    v_cvt_pk_bf16_f32 v242, v244, v245
    v_cvt_pk_bf16_f32 v243, v246, v247
    s_nop 1
    ds_write_b128 v7, v[36:39] offset:1024
    ds_write_b128 v7, v[52:55] offset:41984
    ds_write_b128 v9, v[68:71] offset:1024
    ds_write_b128 v9, v[84:87] offset:41984
    v_mfma_f32_16x16x32_bf16 v[40:43], v[224:227], v[240:243], v[40:43]
    v_mfma_f32_16x16x32_bf16 v[56:59], v[228:231], v[240:243], v[56:59]
    v_mfma_f32_16x16x32_bf16 v[72:75], v[232:235], v[240:243], v[72:75]
    v_mfma_f32_16x16x32_bf16 v[88:91], v[236:239], v[240:243], v[88:91]
    v_add_f32 v200, 0x358637bd, v200
    v_add_f32 v204, 0x358637bd, v204
    v_rcp_f32 v200, v200
    v_rcp_f32 v204, v204
    v_mul_f32 v200, v200, v199
    v_mul_f32 v204, v204, v199
    v_pk_mul_f32 v[248:249], v[248:249], v[200:201] op_sel_hi:[1,0]
    v_pk_mul_f32 v[250:251], v[250:251], v[200:201] op_sel_hi:[1,0]
    v_pk_mul_f32 v[252:253], v[252:253], v[204:205] op_sel_hi:[1,0]
    v_pk_mul_f32 v[254:255], v[254:255], v[204:205] op_sel_hi:[1,0]
    v_cvt_pk_bf16_f32 v248, v248, v249
    v_cvt_pk_bf16_f32 v249, v250, v251
    v_cvt_pk_bf16_f32 v250, v252, v253
    v_cvt_pk_bf16_f32 v251, v254, v255
    s_nop 1
    ds_write_b128 v7, v[40:43] offset:2048
    ds_write_b128 v7, v[56:59] offset:43008
    ds_write_b128 v9, v[72:75] offset:2048
    ds_write_b128 v9, v[88:91] offset:43008
    v_mfma_f32_16x16x32_bf16 v[44:47], v[224:227], v[248:251], v[44:47]
    v_mfma_f32_16x16x32_bf16 v[60:63], v[228:231], v[248:251], v[60:63]
    v_mfma_f32_16x16x32_bf16 v[76:79], v[232:235], v[248:251], v[76:79]
    v_mfma_f32_16x16x32_bf16 v[92:95], v[236:239], v[248:251], v[92:95]
    s_nop 4
    ds_write_b128 v7, v[44:47] offset:3072
    ds_write_b128 v7, v[60:63] offset:44032
    ds_write_b128 v9, v[76:79] offset:3072
    ds_write_b128 v9, v[92:95] offset:44032
    s_lshr_b32 s3, s30, 1
    s_lshl_b32 s3, s3, 5
    s_lshl_b32 s4, s69, 7
    s_add_u32 s3, s3, s4
    v_lshl_add_u32 v8, v4, 3, s3
    buffer_load_dwordx2 v[200:201], v8, s[24:27], 0 offen
    s_waitcnt lgkmcnt(0)
    s_barrier
    s_lshr_b32 s3, s30, 1
    s_mul_i32 s3, s3, 40960
    s_and_b32 s4, s30, 1
    s_lshl_b32 s4, s4, 11
    s_add_u32 s4, s4, s3
    v_lshl_add_u32 v7, v2, 4, s4
    ds_read_b128 v[96:99], v7 offset:0
    ds_read_b128 v[100:103], v7 offset:4096
    ds_read_b128 v[104:107], v7 offset:8192
    ds_read_b128 v[108:111], v7 offset:12288
    ds_read_b128 v[112:115], v7 offset:16384
    ds_read_b128 v[116:119], v7 offset:20480
    ds_read_b128 v[120:123], v7 offset:24576
    ds_read_b128 v[124:127], v7 offset:28672
    ds_read_b128 v[128:131], v7 offset:1024
    ds_read_b128 v[132:135], v7 offset:5120
    ds_read_b128 v[136:139], v7 offset:9216
    ds_read_b128 v[140:143], v7 offset:13312
    ds_read_b128 v[144:147], v7 offset:17408
    ds_read_b128 v[148:151], v7 offset:21504
    ds_read_b128 v[152:155], v7 offset:25600
    ds_read_b128 v[156:159], v7 offset:29696
    s_waitcnt vmcnt(0) lgkmcnt(0)
    v_pk_add_f32 v[96:97], v[96:97], v[112:113]
    v_pk_add_f32 v[98:99], v[98:99], v[114:115]
    v_pk_add_f32 v[100:101], v[100:101], v[116:117]
    v_pk_add_f32 v[102:103], v[102:103], v[118:119]
    v_pk_add_f32 v[104:105], v[104:105], v[120:121]
    v_pk_add_f32 v[106:107], v[106:107], v[122:123]
    v_pk_add_f32 v[108:109], v[108:109], v[124:125]
    v_pk_add_f32 v[110:111], v[110:111], v[126:127]
    v_pk_add_f32 v[96:97], v[96:97], v[104:105]
    v_pk_add_f32 v[98:99], v[98:99], v[106:107]
    v_pk_add_f32 v[100:101], v[100:101], v[108:109]
    v_pk_add_f32 v[102:103], v[102:103], v[110:111]
    v_pk_add_f32 v[96:97], v[96:97], v[100:101]
    v_pk_add_f32 v[98:99], v[98:99], v[102:103]
    v_pk_add_f32 v[128:129], v[128:129], v[144:145]
    v_pk_add_f32 v[130:131], v[130:131], v[146:147]
    v_pk_add_f32 v[132:133], v[132:133], v[148:149]
    v_pk_add_f32 v[134:135], v[134:135], v[150:151]
    v_pk_add_f32 v[136:137], v[136:137], v[152:153]
    v_pk_add_f32 v[138:139], v[138:139], v[154:155]
    v_pk_add_f32 v[140:141], v[140:141], v[156:157]
    v_pk_add_f32 v[142:143], v[142:143], v[158:159]
    v_pk_add_f32 v[128:129], v[128:129], v[136:137]
    v_pk_add_f32 v[130:131], v[130:131], v[138:139]
    v_pk_add_f32 v[132:133], v[132:133], v[140:141]
    v_pk_add_f32 v[134:135], v[134:135], v[142:143]
    v_pk_add_f32 v[128:129], v[128:129], v[132:133]
    v_pk_add_f32 v[130:131], v[130:131], v[134:135]
    v_lshlrev_b32 v204, 16, v200
    v_and_b32 v205, 0xffff0000, v200
    v_lshlrev_b32 v206, 16, v201
    v_and_b32 v207, 0xffff0000, v201
    s_and_b32 s3, s30, 1
    s_cmp_eq_u32 s3, 1
    s_cselect_b64 s[6:7], -1, 0
    v_cndmask_b32 v8, v192, v196, s[6:7]
    v_cndmask_b32 v9, v194, v198, s[6:7]
    v_fma_f32 v96, v204, v8, v96
    v_fma_f32 v97, v205, v8, v97
    v_fma_f32 v98, v206, v8, v98
    v_fma_f32 v99, v207, v8, v99
    v_cvt_pk_bf16_f32 v96, v96, v97
    v_cvt_pk_bf16_f32 v97, v98, v99
    v_fma_f32 v128, v204, v9, v128
    v_fma_f32 v129, v205, v9, v129
    v_fma_f32 v130, v206, v9, v130
    v_fma_f32 v131, v207, v9, v131
    v_cvt_pk_bf16_f32 v128, v128, v129
    v_cvt_pk_bf16_f32 v129, v130, v131
    s_lshl_b32 s3, s33, 6
    s_and_b32 s4, s30, 1
    s_lshl_b32 s4, s4, 5
    s_add_u32 s3, s3, s4
    v_add_u32 v7, s3, v3
    v_lshlrev_b32 v7, 10, v7
    s_lshr_b32 s3, s30, 1
    s_lshl_b32 s3, s3, 5
    s_lshl_b32 s4, s69, 7
    s_add_u32 s3, s3, s4
    v_lshl_add_u32 v8, v4, 3, s3
    v_add_u32 v7, v7, v8
    buffer_store_dwordx2 v[96:97], v7, s[20:23], 0 offen
    v_add_u32 v7, 0x4000, v7
    buffer_store_dwordx2 v[128:129], v7, s[20:23], 0 offen
F_END:
F_EXIT:
    s_endpgm
.section .rodata,"a"
.p2align 6
.amdhsa_kernel fused_kernel
  .amdhsa_next_free_vgpr 256
  .amdhsa_next_free_sgpr 102
  .amdhsa_accum_offset 256
  .amdhsa_group_segment_fixed_size 0
  .amdhsa_kernarg_size 104
  .amdhsa_user_sgpr_count 2
  .amdhsa_user_sgpr_kernarg_segment_ptr 1
  .amdhsa_system_sgpr_workgroup_id_x 1
.end_amdhsa_kernel
```
